```python
import torch

def _softmax(x, axis=-1):
    return torch.softmax(x, dim=axis)
def _gelu(x):
    return torch.nn.functional.gelu(x, approximate="tanh")
def _silu(x):
    return torch.nn.functional.silu(x)
def _sigmoid(x):
    return torch.sigmoid(x)
def _layernorm(x, axis=-1, eps=1e-5):
    m = x.mean(dim=axis, keepdim=True)
    v = x.var(dim=axis, keepdim=True, unbiased=False)
    return (x - m) / torch.sqrt(v + eps)
def _scatter_add(tgt, idx, src, axis=0):
    return tgt.clone().index_add_(axis, idx, src)
def _segment_sum(src, seg, n):
    out = torch.zeros((n,) + src.shape[1:], dtype=src.dtype)
    return out.index_add_(0, seg, src)
def _pad(x, pw):
    flat = tuple(v for pair in reversed(pw) for v in pair)
    return torch.nn.functional.pad(x, flat)

kernel_name = 'sequential_preLN__mha_block_cached__geglu_ffn__decode'

def setup_inputs():

    _w = (lambda a: (lambda t: t.to(torch.bfloat16) if t.is_floating_point() else t)(torch.as_tensor(a)))
    def _A_setup():
        B, Sq, D = 2, 1, 640
        H, Sk, Dh = 32, 16384, 192
        return {
            "x": _w((lambda *s: torch.randn(*s, dtype=torch.bfloat16) * 0.05)(B, Sq, D)),
            "k_cache": _w((lambda *s: torch.randn(*s, dtype=torch.bfloat16) * 3.2)(B, H, Sk, Dh)),
            "v_cache": _w((lambda *s: torch.randn(*s, dtype=torch.bfloat16) * 0.4)(B, H, Sk, Dh)),
            "wq": _w((lambda *s: torch.randn(*s, dtype=torch.bfloat16) * 3.2)(D, H * Dh) * (D ** -0.5)),
            "wo": _w((lambda *s: torch.randn(*s, dtype=torch.bfloat16) * 0.4)(H * Dh, D) * ((H * Dh) ** -0.5)),
        }
    _A_in = _A_setup()

    def _B_setup():
        B, S, D, F = 2, 1, 640, 1536
        return {
            "x": _w((lambda *s: torch.randn(*s, dtype=torch.bfloat16) * 0.05)(B, S, D)),
            "w_gate": _w((lambda *s: torch.randn(*s, dtype=torch.bfloat16) * 0.05)(D, F)),
            "w_up": _w((lambda *s: torch.randn(*s, dtype=torch.bfloat16) * 0.05)(D, F)),
            "w_down": _w((lambda *s: torch.randn(*s, dtype=torch.bfloat16) * 0.05)(F, D)),
        }
    _B_in = _B_setup()

    return {
        "A_x": _A_in["x"],
        "A_k_cache": _A_in["k_cache"],
        "A_v_cache": _A_in["v_cache"],
        "A_wq": _A_in["wq"],
        "A_wo": _A_in["wo"],
        "B_x": _B_in["x"],
        "B_w_gate": _B_in["w_gate"],
        "B_w_up": _B_in["w_up"],
        "B_w_down": _B_in["w_down"],
    }

def reference(A_x, A_k_cache, A_v_cache, A_wq, A_wo, B_x, B_w_gate, B_w_up, B_w_down):
    def _A_ref(x, k_cache, v_cache, wq, wo):
        B, Sq, D = x.shape
        H, Dh = 32, 192
        q = (lambda x, *d: x.permute(*d))((x @ wq).reshape(B, Sq, H, Dh), 0, 2, 1, 3)
        scores = torch.einsum("bhqd,bhkd->bhqk", q, k_cache) * (Dh ** -0.5)
        p = _softmax(scores, axis=-1)
        o = torch.einsum("bhqk,bhkd->bhqd", p, v_cache)
        return (lambda x, *d: x.permute(*d))(o, 0, 2, 1, 3).reshape(B, Sq, H * Dh) @ wo

    def _B_ref(x, w_gate, w_up, w_down):
        return (_gelu(x @ w_gate) * (x @ w_up)) @ w_down

    x = A_x
    h = x + _A_ref(_layernorm(x, axis=-1), A_k_cache, A_v_cache, A_wq, A_wo)
    h2 = h + _B_ref(_layernorm(h, axis=-1), B_w_gate, B_w_up, B_w_down)
    return h2
```

```asm
; @launch grid=(256,1,1) block=(256,1,1) lds=71424
.amdgcn_target "amdgcn-amd-amdhsa--gfx950"
.text
.globl sequential_preLN__mha_block_cached__geglu_ffn__decode_kernel
.p2align 8
.type sequential_preLN__mha_block_cached__geglu_ffn__decode_kernel,@function
sequential_preLN__mha_block_cached__geglu_ffn__decode_kernel:
    s_cmp_ge_u32 s2, 256
    s_cbranch_scc1 L_end_sequential_preLN__mha_block_cached__geglu_ffn__decode_kernel
    s_load_dwordx16 s[16:31], s[0:1], 0
    s_load_dwordx8 s[32:39], s[0:1], 64
    v_and_b32 v1, 63, v0
    v_lshrrev_b32 v68, 6, v0
    s_nop 0
    v_readfirstlane_b32 s48, v68
    v_mov_b32 v26, 1
    s_mov_b32 s64, 0xaaaaaaaa
    s_mov_b32 s65, 0xaaaaaaaa
    s_mov_b32 s66, 0x00ff00ff
    s_mov_b32 s67, 0xff00ff00
    s_mov_b32 s68, 0
    s_mov_b32 s69, 0x80000000
    s_mov_b32 s70, 0x88888888
    s_mov_b32 s71, 0x88888888
    s_mov_b32 s72, 0x44444444
    s_mov_b32 s73, 0x44444444
    s_mov_b32 s74, -1
    s_mov_b32 s75, 0
    s_mov_b32 s88, 0x05040100
    s_mov_b32 s89, 0x07060302
    s_mov_b32 s60, 0
    s_mul_i32 s50, s48, 12288
    v_bfe_u32 v68, v1, 2, 2
    v_lshrrev_b32 v69, 5, v1
    v_lshl_add_u32 v70, v68, 1, v69
    v_mul_u32_u24 v70, 1536, v70
    v_and_b32 v71, 3, v1
    v_lshlrev_b32 v71, 4, v71
    v_bfe_u32 v72, v1, 4, 1
    v_lshl_add_u32 v72, v72, 6, v71
    v_add3_u32 v2, v70, v72, s50
    s_waitcnt lgkmcnt(0)
    s_mov_b32 s4, s18
    s_mov_b32 s5, s19
    s_mov_b32 s6, 402653184
    s_mov_b32 s7, 0x20000
    s_cmp_lt_u32 s2, 96
    s_cbranch_scc1 L_e1_1
    s_and_b32 s50, s2, 0xe0
    s_mul_i32 s50, s50, 3
    s_add_u32 s50, s50, s2
    s_mul_i32 s50, s50, 49152
    buffer_load_dwordx4 a[0:3], v2, s[4:7], s50 offen offset:0 nt
    buffer_load_dwordx4 a[4:7], v2, s[4:7], s50 offen offset:128 nt
    buffer_load_dwordx4 a[8:11], v2, s[4:7], s50 offen offset:256 nt
    buffer_load_dwordx4 a[12:15], v2, s[4:7], s50 offen offset:384 nt
    buffer_load_dwordx4 a[16:19], v2, s[4:7], s50 offen offset:512 nt
    buffer_load_dwordx4 a[20:23], v2, s[4:7], s50 offen offset:640 nt
    buffer_load_dwordx4 a[24:27], v2, s[4:7], s50 offen offset:768 nt
    buffer_load_dwordx4 a[28:31], v2, s[4:7], s50 offen offset:896 nt
    buffer_load_dwordx4 a[32:35], v2, s[4:7], s50 offen offset:1024 nt
    buffer_load_dwordx4 a[36:39], v2, s[4:7], s50 offen offset:1152 nt
    buffer_load_dwordx4 a[40:43], v2, s[4:7], s50 offen offset:1280 nt
    buffer_load_dwordx4 a[44:47], v2, s[4:7], s50 offen offset:1408 nt
    s_branch L_e2_2
L_e1_1:
    s_mov_b32 s44, s16
    s_mov_b32 s45, s17
    s_mov_b32 s46, 2560
    s_mov_b32 s47, 0x20000
    s_mul_i32 s50, s48, 320
    v_lshl_add_u32 v52, v1, 1, s50
    v_mov_b32 v53, 2146435072
    v_cndmask_b32 v53, v53, v52, s[74:75]
    buffer_load_ushort v88, v52, s[44:47], 0 offen offset:0
    buffer_load_ushort v89, v52, s[44:47], 0 offen offset:128
    buffer_load_ushort v90, v53, s[44:47], 0 offen offset:256
    buffer_load_ushort v91, v52, s[44:47], 0 offen offset:1280
    buffer_load_ushort v92, v52, s[44:47], 0 offen offset:1408
    buffer_load_ushort v93, v53, s[44:47], 0 offen offset:1536
    s_mov_b32 s44, s22
    s_mov_b32 s45, s23
    s_mov_b32 s46, 7864320
    s_mov_b32 s47, 0x20000
    s_mul_i32 s50, s48, 1966080
    v_lshrrev_b32 v54, 3, v1
    s_mov_b32 s51, 245760
    v_mul_lo_u32 v54, v54, s51
    v_and_b32 v55, 7, v1
    v_lshlrev_b32 v55, 4, v55
    v_add3_u32 v54, v54, v55, s50
    s_lshl_b32 s50, s2, 7
    buffer_load_dwordx4 v[160:163], v54, s[44:47], s50 offen nt
    s_add_u32 s50, s50, 12288
    buffer_load_dwordx4 v[164:167], v54, s[44:47], s50 offen nt
    s_add_u32 s50, s50, 12288
    buffer_load_dwordx4 v[168:171], v54, s[44:47], s50 offen nt
    s_add_u32 s50, s50, 12288
    buffer_load_dwordx4 v[172:175], v54, s[44:47], s50 offen nt
    s_add_u32 s50, s50, 12288
    buffer_load_dwordx4 v[176:179], v54, s[44:47], s50 offen nt
    s_add_u32 s50, s50, 12288
    buffer_load_dwordx4 v[180:183], v54, s[44:47], s50 offen nt
    s_add_u32 s50, s50, 12288
    buffer_load_dwordx4 v[184:187], v54, s[44:47], s50 offen nt
    s_add_u32 s50, s50, 12288
    buffer_load_dwordx4 v[188:191], v54, s[44:47], s50 offen nt
    s_add_u32 s50, s50, 12288
    buffer_load_dwordx4 v[192:195], v54, s[44:47], s50 offen nt
    s_add_u32 s50, s50, 12288
    buffer_load_dwordx4 v[196:199], v54, s[44:47], s50 offen nt
    s_add_u32 s50, s50, 12288
    buffer_load_dwordx4 v[200:203], v54, s[44:47], s50 offen nt
    s_add_u32 s50, s50, 12288
    buffer_load_dwordx4 v[204:207], v54, s[44:47], s50 offen nt
    s_add_u32 s50, s50, 12288
    buffer_load_dwordx4 v[208:211], v54, s[44:47], s50 offen nt
    s_add_u32 s50, s50, 12288
    buffer_load_dwordx4 v[212:215], v54, s[44:47], s50 offen nt
    s_add_u32 s50, s50, 12288
    buffer_load_dwordx4 v[216:219], v54, s[44:47], s50 offen nt
    s_add_u32 s50, s50, 12288
    buffer_load_dwordx4 v[220:223], v54, s[44:47], s50 offen nt
    s_add_u32 s50, s50, 12288
    buffer_load_dwordx4 v[224:227], v54, s[44:47], s50 offen nt
    s_add_u32 s50, s50, 12288
    buffer_load_dwordx4 v[228:231], v54, s[44:47], s50 offen nt
    s_add_u32 s50, s50, 12288
    buffer_load_dwordx4 v[232:235], v54, s[44:47], s50 offen nt
    s_add_u32 s50, s50, 12288
    buffer_load_dwordx4 v[236:239], v54, s[44:47], s50 offen nt
L_e2_2:
    s_mul_i32 s50, s48, 12288
    v_mov_b32 v73, 24576
    v_lshl_add_u32 v74, v69, 1, 0
    v_cmp_eq_u32 vcc, v68, v74
    s_nop 1
    v_cndmask_b32 v5, 0, 1, vcc
    v_cndmask_b32 v6, v73, v72, vcc
    v_lshl_add_u32 v74, v69, 1, 1
    v_cmp_eq_u32 vcc, v68, v74
    s_nop 1
    v_cndmask_b32 v7, 0, 1, vcc
    v_cndmask_b32 v8, v73, v72, vcc
    v_lshrrev_b32 v73, 3, v1
    v_mul_u32_u24 v70, 1536, v73
    v_and_b32 v74, 7, v1
    v_lshlrev_b32 v75, 4, v74
    v_add3_u32 v3, v70, v75, s50
    v_mov_b32 v76, 0xffff
    v_mov_b32 v77, 0xffff0000
    v_cndmask_b32 v76, v76, v77, s[64:65]
    v_lshrrev_b32 v77, 1, v74
    v_cmp_eq_u32 vcc, 0, v77
    s_nop 1
    v_cndmask_b32 v9, 0, v76, vcc
    v_cmp_eq_u32 vcc, 1, v77
    s_nop 1
    v_cndmask_b32 v10, 0, v76, vcc
    v_cmp_eq_u32 vcc, 2, v77
    s_nop 1
    v_cndmask_b32 v11, 0, v76, vcc
    v_cmp_eq_u32 vcc, 3, v77
    s_nop 1
    v_cndmask_b32 v12, 0, v76, vcc
    s_lshl_b32 s51, s48, 6
    s_add_u32 s52, s51, 25088
    v_lshrrev_b32 v76, 2, v1
    v_and_b32 v77, 1, v1
    v_lshl_add_u32 v76, v76, 1, v77
    v_lshl_add_u32 v13, v76, 1, s52
    v_lshl_add_u32 v14, v73, 3, s52
    v_mov_b32 v78, 2146435072
    s_lshl_b32 s51, s48, 7
    v_cmp_eq_u32 vcc, 0, v0
    s_nop 1
    v_cndmask_b32 v16, v78, 0, vcc
    v_lshlrev_b32 v17, 4, v1
    v_lshl_add_u32 v18, v73, 4, s51
    s_mul_i32 s52, s48, 1536
    s_add_u32 s52, s52, 34560
    v_bfe_u32 v76, v1, 5, 1
    v_mul_u32_u24 v76, 768, v76
    v_bfe_u32 v77, v1, 4, 1
    v_lshl_add_u32 v77, v77, 7, v75
    v_add3_u32 v19, v76, v77, s52
    v_lshrrev_b32 v76, 2, v0
    v_mul_u32_u24 v76, 3, v76
    v_and_b32 v77, 3, v0
    v_min_u32 v77, 2, v77
    v_add_u32 v76, v76, v77
    v_and_b32 v77, 0xe0, v76
    v_and_b32 v79, 7, v76
    v_lshl_add_u32 v77, v79, 2, v77
    v_bfe_u32 v79, v76, 3, 2
    v_add_u32 v77, v77, v79
    v_lshlrev_b32 v77, 2, v77
    v_add_u32 v20, 34560, v77
    v_lshlrev_b32 v21, 2, v0
    s_mov_b32 s12, s38
    s_mov_b32 s13, s39
    s_mov_b32 s14, 8388608
    s_mov_b32 s15, 0x20000
    buffer_load_dword v25, off, s[12:15], 0 offset:0 sc1
    s_mov_b32 s8, s20
    s_mov_b32 s9, s21
    s_mov_b32 s10, 402653184
    s_mov_b32 s11, 0x20000
    s_mov_b32 s40, s36
    s_mov_b32 s41, s37
    s_mov_b32 s42, 256
    s_mov_b32 s43, 0x20000
    s_mov_b32 s87, 0
    s_cmp_ge_u32 s2, 96
    s_cbranch_scc1 L_join_3
    s_lshl_b32 s50, s2, 2
    s_add_u32 s50, s50, s48
    s_lshl_b32 s50, s50, 10
    s_add_u32 s50, s50, 6258688
    s_sub_u32 s51, s50, 6279168
    s_cmp_lt_u32 s51, 6144
    s_cselect_b32 s53, -1, 0
    s_cmp_lt_u32 s50, 6553600
    s_cselect_b32 s51, s50, 2146435072
    v_mov_b32 v76, s53
    v_mov_b32 v77, s53
    v_mov_b32 v78, s53
    v_mov_b32 v79, s53
    buffer_store_dwordx4 v[76:79], v17, s[12:15], s51 offen sc1
    s_lshl_b32 s50, s48, 4
    v_mov_b32 v86, s50
    v_and_b32 v87, 1, v1
    v_lshlrev_b32 v87, 3, v87
    s_waitcnt vmcnt(22)
    v_lshlrev_b32 v88, 16, v88
    v_lshlrev_b32 v89, 16, v89
    v_lshlrev_b32 v90, 16, v90
    v_lshlrev_b32 v91, 16, v91
    v_lshlrev_b32 v92, 16, v92
    v_lshlrev_b32 v93, 16, v93
    v_readlane_b32 s50, v88, 0
    v_readlane_b32 s51, v91, 0
    s_nop 0
    v_subrev_f32 v76, s50, v88
    v_subrev_f32 v79, s51, v91
    v_subrev_f32 v77, s50, v89
    v_subrev_f32 v80, s51, v92
    v_subrev_f32 v78, s50, v90
    v_subrev_f32 v81, s51, v93
    v_cndmask_b32 v78, 0, v78, s[74:75]
    v_cndmask_b32 v81, 0, v81, s[74:75]
    v_add_f32 v68, v76, v77
    v_mul_f32 v69, v76, v76
    v_add_f32 v70, v79, v80
    v_mul_f32 v71, v79, v79
    v_add_f32 v68, v68, v78
    v_fmac_f32 v69, v77, v77
    v_add_f32 v70, v70, v81
    v_fmac_f32 v71, v80, v80
    v_fmac_f32 v69, v78, v78
    v_fmac_f32 v71, v81, v81
    v_add_f32_dpp v68, v68, v68 quad_perm:[1,0,3,2] row_mask:0xf bank_mask:0xf
    v_add_f32_dpp v70, v70, v70 quad_perm:[1,0,3,2] row_mask:0xf bank_mask:0xf
    v_add_f32_dpp v69, v69, v69 quad_perm:[1,0,3,2] row_mask:0xf bank_mask:0xf
    v_add_f32_dpp v71, v71, v71 quad_perm:[1,0,3,2] row_mask:0xf bank_mask:0xf
    v_add_f32_dpp v68, v68, v68 quad_perm:[2,3,0,1] row_mask:0xf bank_mask:0xf
    v_add_f32_dpp v70, v70, v70 quad_perm:[2,3,0,1] row_mask:0xf bank_mask:0xf
    v_add_f32_dpp v69, v69, v69 quad_perm:[2,3,0,1] row_mask:0xf bank_mask:0xf
    v_add_f32_dpp v71, v71, v71 quad_perm:[2,3,0,1] row_mask:0xf bank_mask:0xf
    v_add_f32_dpp v68, v68, v68 row_half_mirror row_mask:0xf bank_mask:0xf
    v_add_f32_dpp v70, v70, v70 row_half_mirror row_mask:0xf bank_mask:0xf
    v_add_f32_dpp v69, v69, v69 row_half_mirror row_mask:0xf bank_mask:0xf
    v_add_f32_dpp v71, v71, v71 row_half_mirror row_mask:0xf bank_mask:0xf
    v_add_f32_dpp v68, v68, v68 row_mirror row_mask:0xf bank_mask:0xf
    v_add_f32_dpp v70, v70, v70 row_mirror row_mask:0xf bank_mask:0xf
    v_add_f32_dpp v69, v69, v69 row_mirror row_mask:0xf bank_mask:0xf
    v_add_f32_dpp v71, v71, v71 row_mirror row_mask:0xf bank_mask:0xf
    v_add_f32_dpp v68, v68, v68 row_bcast:15 row_mask:0xa bank_mask:0xf
    v_add_f32_dpp v70, v70, v70 row_bcast:15 row_mask:0xa bank_mask:0xf
    v_add_f32_dpp v69, v69, v69 row_bcast:15 row_mask:0xa bank_mask:0xf
    v_add_f32_dpp v71, v71, v71 row_bcast:15 row_mask:0xa bank_mask:0xf
    v_add_f32_dpp v68, v68, v68 row_bcast:31 row_mask:0xc bank_mask:0xf
    v_add_f32_dpp v70, v70, v70 row_bcast:31 row_mask:0xc bank_mask:0xf
    v_add_f32_dpp v69, v69, v69 row_bcast:31 row_mask:0xc bank_mask:0xf
    v_add_f32_dpp v71, v71, v71 row_bcast:31 row_mask:0xc bank_mask:0xf
    v_mul_f32 v72, 0x3bcccccd, v68
    v_mul_f32 v73, 0x3bcccccd, v70
    v_fma_f32 v69, -v72, v68, v69
    v_add_f32 v68, s50, v72
    v_fma_f32 v71, -v73, v70, v71
    v_add_f32 v70, s51, v73
    s_mov_b64 exec, s[68:69]
    ds_write_b128 v86, v[68:71] offset:46848
    s_mov_b64 exec, -1
    s_waitcnt lgkmcnt(0)
    s_barrier
    ds_read_b64 v[52:53], v87 offset:46848
    ds_read_b64 v[54:55], v87 offset:46864
    ds_read_b64 v[56:57], v87 offset:46880
    ds_read_b64 v[58:59], v87 offset:46896
    s_waitcnt lgkmcnt(0)
    v_add_f32 v72, v52, v54
    v_add_f32 v74, v56, v58
    v_add_f32 v73, v53, v55
    v_add_f32 v72, v72, v74
    v_add_f32 v74, v57, v59
    v_mul_f32 v72, 0x3e800000, v72
    v_add_f32 v73, v73, v74
    v_sub_f32 v52, v52, v72
    v_sub_f32 v54, v54, v72
    v_sub_f32 v56, v56, v72
    v_sub_f32 v58, v58, v72
    v_mul_f32 v73, 0x3acccccd, v73
    v_mul_f32 v74, v52, v52
    v_fmac_f32 v74, v54, v54
    v_fmac_f32 v74, v56, v56
    v_fmac_f32 v74, v58, v58
    v_cvt_pk_bf16_f32 v72, v72, v72
    v_fmac_f32 v73, 0x3e800000, v74
    v_and_b32 v72, 0xffff0000, v72
    v_max_f32 v73, 0, v73
    v_cvt_pk_bf16_f32 v73, v73, v73
    v_and_b32 v73, 0xffff0000, v73
    v_readlane_b32 s50, v72, 0
    v_readlane_b32 s51, v72, 1
    v_add_f32 v73, 0x3727c5ac, v73
    v_cvt_pk_bf16_f32 v73, v73, v73
    v_and_b32 v73, 0xffff0000, v73
    v_sqrt_f32 v73, v73
    v_subrev_f32 v88, s50, v88
    v_subrev_f32 v89, s50, v89
    v_subrev_f32 v90, s50, v90
    v_subrev_f32 v91, s51, v91
    v_subrev_f32 v92, s51, v92
    v_subrev_f32 v93, s51, v93
    v_cvt_pk_bf16_f32 v73, v73, v73
    v_and_b32 v73, 0xffff0000, v73
    v_rcp_f32 v73, v73
    v_cvt_pk_bf16_f32 v88, v88, v88
    v_cvt_pk_bf16_f32 v89, v89, v89
    v_cvt_pk_bf16_f32 v90, v90, v90
    v_cvt_pk_bf16_f32 v91, v91, v91
    v_cvt_pk_bf16_f32 v92, v92, v92
    v_cvt_pk_bf16_f32 v93, v93, v93
    v_readlane_b32 s52, v73, 0
    v_readlane_b32 s53, v73, 1
    v_and_b32 v88, 0xffff0000, v88
    v_and_b32 v89, 0xffff0000, v89
    v_and_b32 v90, 0xffff0000, v90
    v_and_b32 v91, 0xffff0000, v91
    v_and_b32 v92, 0xffff0000, v92
    v_and_b32 v93, 0xffff0000, v93
    v_mul_f32 v88, s52, v88
    v_mul_f32 v89, s52, v89
    v_mul_f32 v90, s52, v90
    v_mul_f32 v91, s53, v91
    v_mul_f32 v92, s53, v92
    v_mul_f32 v93, s53, v93
    v_cvt_pk_bf16_f32 v88, v88, v88
    v_cvt_pk_bf16_f32 v89, v89, v89
    v_cvt_pk_bf16_f32 v90, v90, v90
    v_cvt_pk_bf16_f32 v91, v91, v91
    v_cvt_pk_bf16_f32 v92, v92, v92
    v_cvt_pk_bf16_f32 v93, v93, v93
    s_and_b32 s50, s2, 0xe0
    s_mul_i32 s50, s50, 3
    s_add_u32 s50, s50, s2
    s_mul_i32 s50, s50, 49152
    buffer_load_dwordx4 a[0:3], v2, s[4:7], s50 offen offset:0 nt
    buffer_load_dwordx4 a[4:7], v2, s[4:7], s50 offen offset:128 nt
    buffer_load_dwordx4 a[8:11], v2, s[4:7], s50 offen offset:256 nt
    buffer_load_dwordx4 a[12:15], v2, s[4:7], s50 offen offset:384 nt
    buffer_load_dwordx4 a[16:19], v2, s[4:7], s50 offen offset:512 nt
    buffer_load_dwordx4 a[20:23], v2, s[4:7], s50 offen offset:640 nt
    buffer_load_dwordx4 a[24:27], v2, s[4:7], s50 offen offset:768 nt
    buffer_load_dwordx4 a[28:31], v2, s[4:7], s50 offen offset:896 nt
    buffer_load_dwordx4 a[32:35], v2, s[4:7], s50 offen offset:1024 nt
    buffer_load_dwordx4 a[36:39], v2, s[4:7], s50 offen offset:1152 nt
    buffer_load_dwordx4 a[40:43], v2, s[4:7], s50 offen offset:1280 nt
    buffer_load_dwordx4 a[44:47], v2, s[4:7], s50 offen offset:1408 nt
    s_mul_i32 s50, s48, 1280
    v_lshl_add_u32 v68, v1, 2, s50
    ds_write_b32 v68, v88 offset:46912
    ds_write_b32 v68, v89 offset:47168
    ds_write_b32 v68, v91 offset:47552
    ds_write_b32 v68, v92 offset:47808
    s_mov_b64 exec, s[74:75]
    ds_write_b32 v68, v90 offset:47424
    ds_write_b32 v68, v93 offset:48064
    s_mov_b64 exec, -1
    v_lshrrev_b32 v69, 3, v1
    v_mul_u32_u24 v69, 80, v69
    v_add_u32 v69, s50, v69
    s_waitcnt lgkmcnt(0)
    ds_read_b128 v[104:107], v69 offset:46912
    ds_read_b128 v[108:111], v69 offset:46928
    ds_read_b128 v[112:115], v69 offset:46944
    ds_read_b128 v[116:119], v69 offset:46960
    ds_read_b128 v[120:123], v69 offset:46976
    ds_read_b128 v[124:127], v69 offset:47552
    ds_read_b128 v[128:131], v69 offset:47568
    ds_read_b128 v[132:135], v69 offset:47584
    ds_read_b128 v[136:139], v69 offset:47600
    ds_read_b128 v[140:143], v69 offset:47616
    s_waitcnt lgkmcnt(0)
    v_and_b32 v28, v104, v9
    v_and_b32 v29, v104, v10
    v_and_b32 v30, v104, v11
    v_and_b32 v31, v104, v12
    s_waitcnt vmcnt(33)
    s_nop 0
    v_mfma_f32_16x16x32_bf16 v[52:55], v[160:163], v[28:31], 0
    v_and_b32 v32, v124, v9
    v_and_b32 v33, v124, v10
    v_and_b32 v34, v124, v11
    v_and_b32 v35, v124, v12
    s_nop 1
    v_mfma_f32_16x16x32_bf16 v[56:59], v[160:163], v[32:35], 0
    v_and_b32 v36, v105, v9
    v_and_b32 v37, v105, v10
    v_and_b32 v38, v105, v11
    v_and_b32 v39, v105, v12
    s_waitcnt vmcnt(32)
    s_nop 0
    v_mfma_f32_16x16x32_bf16 v[52:55], v[164:167], v[36:39], v[52:55]
    v_and_b32 v40, v125, v9
    v_and_b32 v41, v125, v10
    v_and_b32 v42, v125, v11
    v_and_b32 v43, v125, v12
    s_nop 1
    v_mfma_f32_16x16x32_bf16 v[56:59], v[164:167], v[40:43], v[56:59]
    v_and_b32 v28, v106, v9
    v_and_b32 v29, v106, v10
    v_and_b32 v30, v106, v11
    v_and_b32 v31, v106, v12
    s_waitcnt vmcnt(31)
    s_nop 0
    v_mfma_f32_16x16x32_bf16 v[52:55], v[168:171], v[28:31], v[52:55]
    v_and_b32 v32, v126, v9
    v_and_b32 v33, v126, v10
    v_and_b32 v34, v126, v11
    v_and_b32 v35, v126, v12
    s_nop 1
    v_mfma_f32_16x16x32_bf16 v[56:59], v[168:171], v[32:35], v[56:59]
    v_and_b32 v36, v107, v9
    v_and_b32 v37, v107, v10
    v_and_b32 v38, v107, v11
    v_and_b32 v39, v107, v12
    s_waitcnt vmcnt(30)
    s_nop 0
    v_mfma_f32_16x16x32_bf16 v[52:55], v[172:175], v[36:39], v[52:55]
    v_and_b32 v40, v127, v9
    v_and_b32 v41, v127, v10
    v_and_b32 v42, v127, v11
    v_and_b32 v43, v127, v12
    s_nop 1
    v_mfma_f32_16x16x32_bf16 v[56:59], v[172:175], v[40:43], v[56:59]
    v_and_b32 v28, v108, v9
    v_and_b32 v29, v108, v10
    v_and_b32 v30, v108, v11
    v_and_b32 v31, v108, v12
    s_waitcnt vmcnt(29)
    s_nop 0
    v_mfma_f32_16x16x32_bf16 v[52:55], v[176:179], v[28:31], v[52:55]
    v_and_b32 v32, v128, v9
    v_and_b32 v33, v128, v10
    v_and_b32 v34, v128, v11
    v_and_b32 v35, v128, v12
    s_nop 1
    v_mfma_f32_16x16x32_bf16 v[56:59], v[176:179], v[32:35], v[56:59]
    v_and_b32 v36, v109, v9
    v_and_b32 v37, v109, v10
    v_and_b32 v38, v109, v11
    v_and_b32 v39, v109, v12
    s_waitcnt vmcnt(28)
    s_nop 0
    v_mfma_f32_16x16x32_bf16 v[52:55], v[180:183], v[36:39], v[52:55]
    v_and_b32 v40, v129, v9
    v_and_b32 v41, v129, v10
    v_and_b32 v42, v129, v11
    v_and_b32 v43, v129, v12
    s_nop 1
    v_mfma_f32_16x16x32_bf16 v[56:59], v[180:183], v[40:43], v[56:59]
    v_and_b32 v28, v110, v9
    v_and_b32 v29, v110, v10
    v_and_b32 v30, v110, v11
    v_and_b32 v31, v110, v12
    s_waitcnt vmcnt(27)
    s_nop 0
    v_mfma_f32_16x16x32_bf16 v[52:55], v[184:187], v[28:31], v[52:55]
    v_and_b32 v32, v130, v9
    v_and_b32 v33, v130, v10
    v_and_b32 v34, v130, v11
    v_and_b32 v35, v130, v12
    s_nop 1
    v_mfma_f32_16x16x32_bf16 v[56:59], v[184:187], v[32:35], v[56:59]
    v_and_b32 v36, v111, v9
    v_and_b32 v37, v111, v10
    v_and_b32 v38, v111, v11
    v_and_b32 v39, v111, v12
    s_waitcnt vmcnt(26)
    s_nop 0
    v_mfma_f32_16x16x32_bf16 v[52:55], v[188:191], v[36:39], v[52:55]
    v_and_b32 v40, v131, v9
    v_and_b32 v41, v131, v10
    v_and_b32 v42, v131, v11
    v_and_b32 v43, v131, v12
    s_nop 1
    v_mfma_f32_16x16x32_bf16 v[56:59], v[188:191], v[40:43], v[56:59]
    v_and_b32 v28, v112, v9
    v_and_b32 v29, v112, v10
    v_and_b32 v30, v112, v11
    v_and_b32 v31, v112, v12
    s_waitcnt vmcnt(25)
    s_nop 0
    v_mfma_f32_16x16x32_bf16 v[52:55], v[192:195], v[28:31], v[52:55]
    v_and_b32 v32, v132, v9
    v_and_b32 v33, v132, v10
    v_and_b32 v34, v132, v11
    v_and_b32 v35, v132, v12
    s_nop 1
    v_mfma_f32_16x16x32_bf16 v[56:59], v[192:195], v[32:35], v[56:59]
    v_and_b32 v36, v113, v9
    v_and_b32 v37, v113, v10
    v_and_b32 v38, v113, v11
    v_and_b32 v39, v113, v12
    s_waitcnt vmcnt(24)
    s_nop 0
    v_mfma_f32_16x16x32_bf16 v[52:55], v[196:199], v[36:39], v[52:55]
    v_and_b32 v40, v133, v9
    v_and_b32 v41, v133, v10
    v_and_b32 v42, v133, v11
    v_and_b32 v43, v133, v12
    s_nop 1
    v_mfma_f32_16x16x32_bf16 v[56:59], v[196:199], v[40:43], v[56:59]
    v_and_b32 v28, v114, v9
    v_and_b32 v29, v114, v10
    v_and_b32 v30, v114, v11
    v_and_b32 v31, v114, v12
    s_waitcnt vmcnt(23)
    s_nop 0
    v_mfma_f32_16x16x32_bf16 v[52:55], v[200:203], v[28:31], v[52:55]
    v_and_b32 v32, v134, v9
    v_and_b32 v33, v134, v10
    v_and_b32 v34, v134, v11
    v_and_b32 v35, v134, v12
    s_nop 1
    v_mfma_f32_16x16x32_bf16 v[56:59], v[200:203], v[32:35], v[56:59]
    v_and_b32 v36, v115, v9
    v_and_b32 v37, v115, v10
    v_and_b32 v38, v115, v11
    v_and_b32 v39, v115, v12
    s_waitcnt vmcnt(22)
    s_nop 0
    v_mfma_f32_16x16x32_bf16 v[52:55], v[204:207], v[36:39], v[52:55]
    v_and_b32 v40, v135, v9
    v_and_b32 v41, v135, v10
    v_and_b32 v42, v135, v11
    v_and_b32 v43, v135, v12
    s_nop 1
    v_mfma_f32_16x16x32_bf16 v[56:59], v[204:207], v[40:43], v[56:59]
    v_and_b32 v28, v116, v9
    v_and_b32 v29, v116, v10
    v_and_b32 v30, v116, v11
    v_and_b32 v31, v116, v12
    s_waitcnt vmcnt(21)
    s_nop 0
    v_mfma_f32_16x16x32_bf16 v[52:55], v[208:211], v[28:31], v[52:55]
    v_and_b32 v32, v136, v9
    v_and_b32 v33, v136, v10
    v_and_b32 v34, v136, v11
    v_and_b32 v35, v136, v12
    s_nop 1
    v_mfma_f32_16x16x32_bf16 v[56:59], v[208:211], v[32:35], v[56:59]
    v_and_b32 v36, v117, v9
    v_and_b32 v37, v117, v10
    v_and_b32 v38, v117, v11
    v_and_b32 v39, v117, v12
    s_waitcnt vmcnt(20)
    s_nop 0
    v_mfma_f32_16x16x32_bf16 v[52:55], v[212:215], v[36:39], v[52:55]
    v_and_b32 v40, v137, v9
    v_and_b32 v41, v137, v10
    v_and_b32 v42, v137, v11
    v_and_b32 v43, v137, v12
    s_nop 1
    v_mfma_f32_16x16x32_bf16 v[56:59], v[212:215], v[40:43], v[56:59]
    v_and_b32 v28, v118, v9
    v_and_b32 v29, v118, v10
    v_and_b32 v30, v118, v11
    v_and_b32 v31, v118, v12
    s_waitcnt vmcnt(19)
    s_nop 0
    v_mfma_f32_16x16x32_bf16 v[52:55], v[216:219], v[28:31], v[52:55]
    v_and_b32 v32, v138, v9
    v_and_b32 v33, v138, v10
    v_and_b32 v34, v138, v11
    v_and_b32 v35, v138, v12
    s_nop 1
    v_mfma_f32_16x16x32_bf16 v[56:59], v[216:219], v[32:35], v[56:59]
    v_and_b32 v36, v119, v9
    v_and_b32 v37, v119, v10
    v_and_b32 v38, v119, v11
    v_and_b32 v39, v119, v12
    s_waitcnt vmcnt(18)
    s_nop 0
    v_mfma_f32_16x16x32_bf16 v[52:55], v[220:223], v[36:39], v[52:55]
    v_and_b32 v40, v139, v9
    v_and_b32 v41, v139, v10
    v_and_b32 v42, v139, v11
    v_and_b32 v43, v139, v12
    s_nop 1
    v_mfma_f32_16x16x32_bf16 v[56:59], v[220:223], v[40:43], v[56:59]
    v_and_b32 v28, v120, v9
    v_and_b32 v29, v120, v10
    v_and_b32 v30, v120, v11
    v_and_b32 v31, v120, v12
    s_waitcnt vmcnt(17)
    s_nop 0
    v_mfma_f32_16x16x32_bf16 v[52:55], v[224:227], v[28:31], v[52:55]
    v_and_b32 v32, v140, v9
    v_and_b32 v33, v140, v10
    v_and_b32 v34, v140, v11
    v_and_b32 v35, v140, v12
    s_nop 1
    v_mfma_f32_16x16x32_bf16 v[56:59], v[224:227], v[32:35], v[56:59]
    v_and_b32 v36, v121, v9
    v_and_b32 v37, v121, v10
    v_and_b32 v38, v121, v11
    v_and_b32 v39, v121, v12
    s_waitcnt vmcnt(16)
    s_nop 0
    v_mfma_f32_16x16x32_bf16 v[52:55], v[228:231], v[36:39], v[52:55]
    v_and_b32 v40, v141, v9
    v_and_b32 v41, v141, v10
    v_and_b32 v42, v141, v11
    v_and_b32 v43, v141, v12
    s_nop 1
    v_mfma_f32_16x16x32_bf16 v[56:59], v[228:231], v[40:43], v[56:59]
    v_and_b32 v28, v122, v9
    v_and_b32 v29, v122, v10
    v_and_b32 v30, v122, v11
    v_and_b32 v31, v122, v12
    s_waitcnt vmcnt(15)
    s_nop 0
    v_mfma_f32_16x16x32_bf16 v[52:55], v[232:235], v[28:31], v[52:55]
    v_and_b32 v32, v142, v9
    v_and_b32 v33, v142, v10
    v_and_b32 v34, v142, v11
    v_and_b32 v35, v142, v12
    s_nop 1
    v_mfma_f32_16x16x32_bf16 v[56:59], v[232:235], v[32:35], v[56:59]
    v_and_b32 v36, v123, v9
    v_and_b32 v37, v123, v10
    v_and_b32 v38, v123, v11
    v_and_b32 v39, v123, v12
    s_waitcnt vmcnt(14)
    s_nop 0
    v_mfma_f32_16x16x32_bf16 v[52:55], v[236:239], v[36:39], v[52:55]
    v_and_b32 v40, v143, v9
    v_and_b32 v41, v143, v10
    v_and_b32 v42, v143, v11
    v_and_b32 v43, v143, v12
    s_nop 1
    v_mfma_f32_16x16x32_bf16 v[56:59], v[236:239], v[40:43], v[56:59]
    s_mov_b64 exec, s[66:67]
    ds_write_b128 v19, v[52:55] offset:0
    s_nop 5
    ds_write_b128 v19, v[56:59] offset:256
    s_mov_b64 exec, -1
    v_and_b32 v68, 32, v1
    v_and_b32 v69, 7, v1
    v_lshl_add_u32 v68, v69, 2, v68
    v_bfe_u32 v69, v1, 3, 2
    v_add_u32 v68, v68, v69
    s_and_b32 s51, s48, 1
    s_lshl_b32 s50, s51, 8
    s_add_u32 s50, s50, 34560
    v_lshl_add_u32 v68, v68, 2, s50
    s_waitcnt vmcnt(12) lgkmcnt(0)
    v_readfirstlane_b32 s57, v25
    s_nop 0
    s_mul_i32 s57, s57, 0x9e3779b1
    s_add_u32 s57, s57, 0x7f4a7c15
    s_barrier
    ds_read2st64_b32 v[72:73], v68 offset0:0 offset1:3
    ds_read2st64_b32 v[74:75], v68 offset0:6 offset1:9
    ds_read2st64_b32 v[76:77], v68 offset0:12 offset1:15
    ds_read2st64_b32 v[78:79], v68 offset0:18 offset1:21
    v_and_b32 v69, 3, v1
    v_cmp_eq_u32 vcc, 0, v69
    v_lshlrev_b32 v70, 2, v1
    v_mov_b32 v69, 2146435072
    v_cndmask_b32 v69, v69, v70, vcc
    s_mul_i32 s50, s48, 24576
    s_lshl_b32 s51, s2, 8
    s_add_u32 s50, s50, s51
    s_add_u32 s50, s50, 4096
    s_cmp_lt_u32 s48, 2
    s_cselect_b32 s50, s50, 2146435072
    v_mov_b32 v82, s57
    s_waitcnt lgkmcnt(0)
    v_add_f32 v72, v72, v73
    v_add_f32 v74, v74, v75
    v_add_f32 v76, v76, v77
    v_add_f32 v78, v78, v79
    v_add_f32 v72, v72, v74
    v_add_f32 v76, v76, v78
    v_add_f32 v72, v72, v76
    s_nop 1
    v_mov_b32_dpp v73, v72 quad_perm:[1,1,3,3] row_mask:0xf bank_mask:0xf
    v_cvt_pk_bf16_f32 v80, v72, v73
    s_nop 1
    v_mov_b32_dpp v81, v80 quad_perm:[2,2,2,2] row_mask:0xf bank_mask:0xf
    buffer_store_dwordx4 v[80:83], v69, s[12:15], s50 offen sc1
L_join_3:
    s_and_b32 s50, s2, 0xe0
    s_mul_i32 s50, s50, 3
    s_add_u32 s50, s50, s2
    s_mul_i32 s50, s50, 49152
    s_add_u32 s50, s50, 1572864
    buffer_load_dwordx4 a[48:51], v2, s[4:7], s50 offen offset:0 nt
    buffer_load_dwordx4 a[52:55], v2, s[4:7], s50 offen offset:128 nt
    buffer_load_dwordx4 a[56:59], v2, s[4:7], s50 offen offset:256 nt
    buffer_load_dwordx4 a[60:63], v2, s[4:7], s50 offen offset:384 nt
    buffer_load_dwordx4 a[64:67], v2, s[4:7], s50 offen offset:512 nt
    buffer_load_dwordx4 a[68:71], v2, s[4:7], s50 offen offset:640 nt
    buffer_load_dwordx4 a[72:75], v2, s[4:7], s50 offen offset:768 nt
    buffer_load_dwordx4 a[76:79], v2, s[4:7], s50 offen offset:896 nt
    buffer_load_dwordx4 a[80:83], v2, s[4:7], s50 offen offset:1024 nt
    buffer_load_dwordx4 a[84:87], v2, s[4:7], s50 offen offset:1152 nt
    buffer_load_dwordx4 a[88:91], v2, s[4:7], s50 offen offset:1280 nt
    buffer_load_dwordx4 a[92:95], v2, s[4:7], s50 offen offset:1408 nt
    v_mov_b32 v72, 0
    v_mov_b32 v73, 0
    v_lshrrev_b32 v74, 1, v0
    v_lshlrev_b32 v74, 2, v74
    ds_write_b32 v74, v72 offset:24576
    ds_write_b32 v72, v72 offset:34368
    s_mov_b32 s39, 1
    s_sub_u32 s50, s2, 96
    s_cmp_lt_u32 s50, 80
    s_cbranch_scc0 L_wr_5
    s_mov_b32 s39, 0
    s_sub_u32 s51, s2, 96
    s_mul_i32 s50, s51, 6554
    s_lshr_b32 s50, s50, 16
    s_mul_i32 s52, s50, 10
    s_sub_u32 s51, s51, s52
    s_lshl_b32 s50, s50, 2
    s_add_u32 s50, s50, s48
    s_mul_i32 s26, s50, 245760
    s_lshl_b32 s51, s51, 7
    s_add_u32 s26, s26, s51
    v_lshrrev_b32 v68, 3, v1
    v_mul_u32_u24 v68, 1280, v68
    v_and_b32 v69, 7, v1
    v_lshl_add_u32 v158, v69, 4, v68
    s_mov_b32 s44, s24
    s_mov_b32 s45, s25
    s_mov_b32 s46, 7864320
    s_mov_b32 s47, 0x20000
    s_mov_b32 s36, s26
    buffer_load_dwordx4 v[160:163], v158, s[44:47], s36 offen nt
    s_add_u32 s36, s36, 10240
    buffer_load_dwordx4 v[164:167], v158, s[44:47], s36 offen nt
    s_add_u32 s36, s36, 10240
    buffer_load_dwordx4 v[168:171], v158, s[44:47], s36 offen nt
    s_add_u32 s36, s36, 10240
    buffer_load_dwordx4 v[172:175], v158, s[44:47], s36 offen nt
    s_add_u32 s36, s36, 10240
    buffer_load_dwordx4 v[176:179], v158, s[44:47], s36 offen nt
    s_add_u32 s36, s36, 10240
    buffer_load_dwordx4 v[180:183], v158, s[44:47], s36 offen nt
    s_add_u32 s36, s36, 10240
    buffer_load_dwordx4 v[184:187], v158, s[44:47], s36 offen nt
    s_add_u32 s36, s36, 10240
    buffer_load_dwordx4 v[188:191], v158, s[44:47], s36 offen nt
    s_add_u32 s36, s36, 10240
    buffer_load_dwordx4 v[192:195], v158, s[44:47], s36 offen nt
    s_add_u32 s36, s36, 10240
    buffer_load_dwordx4 v[196:199], v158, s[44:47], s36 offen nt
    s_add_u32 s36, s36, 10240
    buffer_load_dwordx4 v[200:203], v158, s[44:47], s36 offen nt
    s_add_u32 s36, s36, 10240
    buffer_load_dwordx4 v[204:207], v158, s[44:47], s36 offen nt
    s_add_u32 s36, s36, 10240
    buffer_load_dwordx4 v[208:211], v158, s[44:47], s36 offen nt
    s_add_u32 s36, s36, 10240
    buffer_load_dwordx4 v[212:215], v158, s[44:47], s36 offen nt
    s_add_u32 s36, s36, 10240
    buffer_load_dwordx4 v[216:219], v158, s[44:47], s36 offen nt
    s_add_u32 s36, s36, 10240
    buffer_load_dwordx4 v[220:223], v158, s[44:47], s36 offen nt
    s_add_u32 s36, s36, 10240
    buffer_load_dwordx4 v[224:227], v158, s[44:47], s36 offen nt
    s_add_u32 s36, s36, 10240
    buffer_load_dwordx4 v[228:231], v158, s[44:47], s36 offen nt
    s_add_u32 s36, s36, 10240
    buffer_load_dwordx4 v[232:235], v158, s[44:47], s36 offen nt
    s_add_u32 s36, s36, 10240
    buffer_load_dwordx4 v[236:239], v158, s[44:47], s36 offen nt
    s_add_u32 s36, s36, 10240
    buffer_load_dwordx4 v[240:243], v158, s[44:47], s36 offen nt
    s_add_u32 s36, s36, 10240
    buffer_load_dwordx4 v[244:247], v158, s[44:47], s36 offen nt
    s_add_u32 s36, s36, 10240
    buffer_load_dwordx4 v[248:251], v158, s[44:47], s36 offen nt
    s_add_u32 s36, s36, 10240
    buffer_load_dwordx4 v[252:255], v158, s[44:47], s36 offen nt
    s_branch L_wdone_4
L_wr_5:
    s_sub_u32 s50, s2, 176
    s_cmp_lt_u32 s50, 24
    s_cbranch_scc0 L_wr_6
    s_mov_b32 s39, 0
    s_sub_u32 s50, s2, 176
    s_lshl_b32 s50, s50, 7
    s_mul_i32 s51, s48, 491520
    s_add_u32 s26, s50, s51
    v_lshrrev_b32 v68, 3, v1
    v_mul_u32_u24 v68, 3072, v68
    v_and_b32 v69, 7, v1
    v_lshl_add_u32 v158, v69, 4, v68
    s_mov_b32 s44, s28
    s_mov_b32 s45, s29
    s_mov_b32 s46, 1966080
    s_mov_b32 s47, 0x20000
    s_mov_b32 s36, s26
    buffer_load_dwordx4 v[160:163], v158, s[44:47], s36 offen nt
    s_add_u32 s36, s36, 24576
    buffer_load_dwordx4 v[164:167], v158, s[44:47], s36 offen nt
    s_add_u32 s36, s36, 24576
    buffer_load_dwordx4 v[168:171], v158, s[44:47], s36 offen nt
    s_add_u32 s36, s36, 24576
    buffer_load_dwordx4 v[172:175], v158, s[44:47], s36 offen nt
    s_add_u32 s36, s36, 24576
    buffer_load_dwordx4 v[176:179], v158, s[44:47], s36 offen nt
    s_add_u32 s36, s36, 24576
    buffer_load_dwordx4 v[180:183], v158, s[44:47], s36 offen nt
    s_add_u32 s36, s36, 24576
    buffer_load_dwordx4 v[184:187], v158, s[44:47], s36 offen nt
    s_add_u32 s36, s36, 24576
    buffer_load_dwordx4 v[188:191], v158, s[44:47], s36 offen nt
    s_add_u32 s36, s36, 24576
    buffer_load_dwordx4 v[192:195], v158, s[44:47], s36 offen nt
    s_add_u32 s36, s36, 24576
    buffer_load_dwordx4 v[196:199], v158, s[44:47], s36 offen nt
    s_add_u32 s36, s36, 24576
    buffer_load_dwordx4 v[200:203], v158, s[44:47], s36 offen nt
    s_add_u32 s36, s36, 24576
    buffer_load_dwordx4 v[204:207], v158, s[44:47], s36 offen nt
    s_add_u32 s36, s36, 24576
    buffer_load_dwordx4 v[208:211], v158, s[44:47], s36 offen nt
    s_add_u32 s36, s36, 24576
    buffer_load_dwordx4 v[212:215], v158, s[44:47], s36 offen nt
    s_add_u32 s36, s36, 24576
    buffer_load_dwordx4 v[216:219], v158, s[44:47], s36 offen nt
    s_add_u32 s36, s36, 24576
    buffer_load_dwordx4 v[220:223], v158, s[44:47], s36 offen nt
    s_add_u32 s36, s36, 24576
    buffer_load_dwordx4 v[224:227], v158, s[44:47], s36 offen nt
    s_add_u32 s36, s36, 24576
    buffer_load_dwordx4 v[228:231], v158, s[44:47], s36 offen nt
    s_add_u32 s36, s36, 24576
    buffer_load_dwordx4 v[232:235], v158, s[44:47], s36 offen nt
    s_add_u32 s36, s36, 24576
    buffer_load_dwordx4 v[236:239], v158, s[44:47], s36 offen nt
    s_mov_b32 s44, s30
    s_mov_b32 s45, s31
    s_mov_b32 s46, 1966080
    s_mov_b32 s47, 0x20000
    s_mov_b32 s36, s26
    buffer_load_dwordx4 v[240:243], v158, s[44:47], s36 offen nt
    s_add_u32 s36, s36, 24576
    buffer_load_dwordx4 v[244:247], v158, s[44:47], s36 offen nt
    s_add_u32 s36, s36, 24576
    buffer_load_dwordx4 v[248:251], v158, s[44:47], s36 offen nt
    s_add_u32 s36, s36, 24576
    buffer_load_dwordx4 v[252:255], v158, s[44:47], s36 offen nt
    s_add_u32 s36, s36, 24576
    buffer_load_dwordx4 a[192:195], v158, s[44:47], s36 offen nt
    s_add_u32 s36, s36, 24576
    buffer_load_dwordx4 a[196:199], v158, s[44:47], s36 offen nt
    s_add_u32 s36, s36, 24576
    buffer_load_dwordx4 a[200:203], v158, s[44:47], s36 offen nt
    s_add_u32 s36, s36, 24576
    buffer_load_dwordx4 a[204:207], v158, s[44:47], s36 offen nt
    s_add_u32 s36, s36, 24576
    buffer_load_dwordx4 a[208:211], v158, s[44:47], s36 offen nt
    s_add_u32 s36, s36, 24576
    buffer_load_dwordx4 a[212:215], v158, s[44:47], s36 offen nt
    s_add_u32 s36, s36, 24576
    buffer_load_dwordx4 a[216:219], v158, s[44:47], s36 offen nt
    s_add_u32 s36, s36, 24576
    buffer_load_dwordx4 a[220:223], v158, s[44:47], s36 offen nt
    s_add_u32 s36, s36, 24576
    buffer_load_dwordx4 a[224:227], v158, s[44:47], s36 offen nt
    s_add_u32 s36, s36, 24576
    buffer_load_dwordx4 a[228:231], v158, s[44:47], s36 offen nt
    s_add_u32 s36, s36, 24576
    buffer_load_dwordx4 a[232:235], v158, s[44:47], s36 offen nt
    s_add_u32 s36, s36, 24576
    buffer_load_dwordx4 a[236:239], v158, s[44:47], s36 offen nt
    s_add_u32 s36, s36, 24576
    buffer_load_dwordx4 a[240:243], v158, s[44:47], s36 offen nt
    s_add_u32 s36, s36, 24576
    s_waitcnt vmcnt(62)
    buffer_load_dwordx4 a[244:247], v158, s[44:47], s36 offen nt
    s_add_u32 s36, s36, 24576
    s_waitcnt vmcnt(62)
    buffer_load_dwordx4 a[248:251], v158, s[44:47], s36 offen nt
    s_add_u32 s36, s36, 24576
    s_waitcnt vmcnt(62)
    buffer_load_dwordx4 a[252:255], v158, s[44:47], s36 offen nt
    s_branch L_wdone_4
L_wr_6:
    s_sub_u32 s50, s2, 200
    s_cmp_lt_u32 s50, 20
    s_cbranch_scc0 L_wr_7
    s_mov_b32 s39, 0
    s_sub_u32 s50, s2, 200
    s_lshl_b32 s50, s50, 6
    s_mul_i32 s51, s48, 491520
    s_add_u32 s26, s50, s51
    v_lshrrev_b32 v68, 2, v1
    v_mul_u32_u24 v68, 1280, v68
    v_and_b32 v69, 3, v1
    v_lshl_add_u32 v158, v69, 4, v68
    s_mov_b32 s44, s32
    s_mov_b32 s45, s33
    s_mov_b32 s46, 1966080
    s_mov_b32 s47, 0x20000
    s_mov_b32 s36, s26
    buffer_load_dwordx4 v[160:163], v158, s[44:47], s36 offen nt
    s_add_u32 s36, s36, 20480
    buffer_load_dwordx4 v[164:167], v158, s[44:47], s36 offen nt
    s_add_u32 s36, s36, 20480
    buffer_load_dwordx4 v[168:171], v158, s[44:47], s36 offen nt
    s_add_u32 s36, s36, 20480
    buffer_load_dwordx4 v[172:175], v158, s[44:47], s36 offen nt
    s_add_u32 s36, s36, 20480
    buffer_load_dwordx4 v[176:179], v158, s[44:47], s36 offen nt
    s_add_u32 s36, s36, 20480
    buffer_load_dwordx4 v[180:183], v158, s[44:47], s36 offen nt
    s_add_u32 s36, s36, 20480
    buffer_load_dwordx4 v[184:187], v158, s[44:47], s36 offen nt
    s_add_u32 s36, s36, 20480
    buffer_load_dwordx4 v[188:191], v158, s[44:47], s36 offen nt
    s_add_u32 s36, s36, 20480
    buffer_load_dwordx4 v[192:195], v158, s[44:47], s36 offen nt
    s_add_u32 s36, s36, 20480
    buffer_load_dwordx4 v[196:199], v158, s[44:47], s36 offen nt
    s_add_u32 s36, s36, 20480
    buffer_load_dwordx4 v[200:203], v158, s[44:47], s36 offen nt
    s_add_u32 s36, s36, 20480
    buffer_load_dwordx4 v[204:207], v158, s[44:47], s36 offen nt
    s_add_u32 s36, s36, 20480
    buffer_load_dwordx4 v[208:211], v158, s[44:47], s36 offen nt
    s_add_u32 s36, s36, 20480
    buffer_load_dwordx4 v[212:215], v158, s[44:47], s36 offen nt
    s_add_u32 s36, s36, 20480
    buffer_load_dwordx4 v[216:219], v158, s[44:47], s36 offen nt
    s_add_u32 s36, s36, 20480
    buffer_load_dwordx4 v[220:223], v158, s[44:47], s36 offen nt
    s_add_u32 s36, s36, 20480
    buffer_load_dwordx4 v[224:227], v158, s[44:47], s36 offen nt
    s_add_u32 s36, s36, 20480
    buffer_load_dwordx4 v[228:231], v158, s[44:47], s36 offen nt
    s_add_u32 s36, s36, 20480
    buffer_load_dwordx4 v[232:235], v158, s[44:47], s36 offen nt
    s_add_u32 s36, s36, 20480
    buffer_load_dwordx4 v[236:239], v158, s[44:47], s36 offen nt
    s_add_u32 s36, s36, 20480
    buffer_load_dwordx4 v[240:243], v158, s[44:47], s36 offen nt
    s_add_u32 s36, s36, 20480
    buffer_load_dwordx4 v[244:247], v158, s[44:47], s36 offen nt
    s_add_u32 s36, s36, 20480
    buffer_load_dwordx4 v[248:251], v158, s[44:47], s36 offen nt
    s_add_u32 s36, s36, 20480
    buffer_load_dwordx4 v[252:255], v158, s[44:47], s36 offen nt
    s_branch L_wdone_4
L_wr_7:
L_wdone_4:
    s_cmp_eq_u32 s39, 0
    s_cbranch_scc1 L_z1_8
    s_and_b32 s50, s2, 0xe0
    s_mul_i32 s50, s50, 3
    s_add_u32 s50, s50, s2
    s_mul_i32 s50, s50, 49152
    s_add_u32 s50, s50, 3145728
    s_waitcnt vmcnt(62)
    buffer_load_dwordx4 a[96:99], v2, s[4:7], s50 offen offset:0 nt
    s_waitcnt vmcnt(62)
    buffer_load_dwordx4 a[100:103], v2, s[4:7], s50 offen offset:128 nt
    s_waitcnt vmcnt(62)
    buffer_load_dwordx4 a[104:107], v2, s[4:7], s50 offen offset:256 nt
    s_waitcnt vmcnt(62)
    buffer_load_dwordx4 a[108:111], v2, s[4:7], s50 offen offset:384 nt
    s_waitcnt vmcnt(62)
    buffer_load_dwordx4 a[112:115], v2, s[4:7], s50 offen offset:512 nt
    s_waitcnt vmcnt(62)
    buffer_load_dwordx4 a[116:119], v2, s[4:7], s50 offen offset:640 nt
    s_waitcnt vmcnt(62)
    buffer_load_dwordx4 a[120:123], v2, s[4:7], s50 offen offset:768 nt
    s_waitcnt vmcnt(62)
    buffer_load_dwordx4 a[124:127], v2, s[4:7], s50 offen offset:896 nt
    s_waitcnt vmcnt(62)
    buffer_load_dwordx4 a[128:131], v2, s[4:7], s50 offen offset:1024 nt
    s_waitcnt vmcnt(62)
    buffer_load_dwordx4 a[132:135], v2, s[4:7], s50 offen offset:1152 nt
    s_waitcnt vmcnt(62)
    buffer_load_dwordx4 a[136:139], v2, s[4:7], s50 offen offset:1280 nt
    s_waitcnt vmcnt(62)
    buffer_load_dwordx4 a[140:143], v2, s[4:7], s50 offen offset:1408 nt
    v_lshlrev_b32 v4, 4, v0
    s_mov_b32 s50, 4096
    s_waitcnt vmcnt(62)
    buffer_load_dwordx4 v[88:91], v4, s[12:15], s50 offen sc1
    s_add_u32 s50, s50, 4096
    s_waitcnt vmcnt(62)
    buffer_load_dwordx4 v[92:95], v4, s[12:15], s50 offen sc1
    s_add_u32 s50, s50, 4096
    s_waitcnt vmcnt(62)
    buffer_load_dwordx4 v[96:99], v4, s[12:15], s50 offen sc1
    s_add_u32 s50, s50, 4096
    s_waitcnt vmcnt(62)
    buffer_load_dwordx4 v[100:103], v4, s[12:15], s50 offen sc1
    s_add_u32 s50, s50, 4096
    s_waitcnt vmcnt(62)
    buffer_load_dwordx4 v[104:107], v4, s[12:15], s50 offen sc1
    s_add_u32 s50, s50, 4096
    s_waitcnt vmcnt(62)
    buffer_load_dwordx4 v[108:111], v4, s[12:15], s50 offen sc1
    s_add_u32 s50, s50, 4096
    s_waitcnt vmcnt(62)
    buffer_load_dwordx4 v[112:115], v4, s[12:15], s50 offen sc1
    s_add_u32 s50, s50, 4096
    s_waitcnt vmcnt(62)
    buffer_load_dwordx4 v[116:119], v4, s[12:15], s50 offen sc1
    s_add_u32 s50, s50, 4096
    s_waitcnt vmcnt(62)
    buffer_load_dwordx4 v[120:123], v4, s[12:15], s50 offen sc1
    s_add_u32 s50, s50, 4096
    s_waitcnt vmcnt(62)
    buffer_load_dwordx4 v[124:127], v4, s[12:15], s50 offen sc1
    s_add_u32 s50, s50, 4096
    s_waitcnt vmcnt(62)
    buffer_load_dwordx4 v[128:131], v4, s[12:15], s50 offen sc1
    s_add_u32 s50, s50, 4096
    s_waitcnt vmcnt(62)
    buffer_load_dwordx4 v[132:135], v4, s[12:15], s50 offen sc1
    s_and_b32 s50, s2, 0xe0
    s_mul_i32 s50, s50, 3
    s_add_u32 s50, s50, s2
    s_mul_i32 s50, s50, 49152
    s_add_u32 s50, s50, 4718592
    s_waitcnt vmcnt(62)
    buffer_load_dwordx4 a[144:147], v2, s[4:7], s50 offen offset:0 nt
    s_waitcnt vmcnt(62)
    buffer_load_dwordx4 a[148:151], v2, s[4:7], s50 offen offset:128 nt
    s_waitcnt vmcnt(62)
    buffer_load_dwordx4 a[152:155], v2, s[4:7], s50 offen offset:256 nt
    s_waitcnt vmcnt(62)
    buffer_load_dwordx4 a[156:159], v2, s[4:7], s50 offen offset:384 nt
    s_waitcnt vmcnt(62)
    buffer_load_dwordx4 a[160:163], v2, s[4:7], s50 offen offset:512 nt
    s_waitcnt vmcnt(62)
    buffer_load_dwordx4 a[164:167], v2, s[4:7], s50 offen offset:640 nt
    s_waitcnt vmcnt(62)
    buffer_load_dwordx4 a[168:171], v2, s[4:7], s50 offen offset:768 nt
    s_waitcnt vmcnt(62)
    buffer_load_dwordx4 a[172:175], v2, s[4:7], s50 offen offset:896 nt
    s_waitcnt vmcnt(62)
    buffer_load_dwordx4 a[176:179], v2, s[4:7], s50 offen offset:1024 nt
    s_waitcnt vmcnt(62)
    buffer_load_dwordx4 a[180:183], v2, s[4:7], s50 offen offset:1152 nt
    s_waitcnt vmcnt(62)
    buffer_load_dwordx4 a[184:187], v2, s[4:7], s50 offen offset:1280 nt
    s_waitcnt vmcnt(62)
    buffer_load_dwordx4 a[188:191], v2, s[4:7], s50 offen offset:1408 nt
    s_waitcnt vmcnt(12)
    s_branch L_z2_9
L_z1_8:
    v_lshlrev_b32 v4, 4, v0
    s_mov_b32 s50, 4096
    s_waitcnt vmcnt(62)
    buffer_load_dwordx4 v[88:91], v4, s[12:15], s50 offen sc1
    s_add_u32 s50, s50, 4096
    s_waitcnt vmcnt(62)
    buffer_load_dwordx4 v[92:95], v4, s[12:15], s50 offen sc1
    s_add_u32 s50, s50, 4096
    s_waitcnt vmcnt(62)
    buffer_load_dwordx4 v[96:99], v4, s[12:15], s50 offen sc1
    s_add_u32 s50, s50, 4096
    s_waitcnt vmcnt(62)
    buffer_load_dwordx4 v[100:103], v4, s[12:15], s50 offen sc1
    s_add_u32 s50, s50, 4096
    s_waitcnt vmcnt(62)
    buffer_load_dwordx4 v[104:107], v4, s[12:15], s50 offen sc1
    s_add_u32 s50, s50, 4096
    s_waitcnt vmcnt(62)
    buffer_load_dwordx4 v[108:111], v4, s[12:15], s50 offen sc1
    s_add_u32 s50, s50, 4096
    s_waitcnt vmcnt(62)
    buffer_load_dwordx4 v[112:115], v4, s[12:15], s50 offen sc1
    s_add_u32 s50, s50, 4096
    s_waitcnt vmcnt(62)
    buffer_load_dwordx4 v[116:119], v4, s[12:15], s50 offen sc1
    s_add_u32 s50, s50, 4096
    s_waitcnt vmcnt(62)
    buffer_load_dwordx4 v[120:123], v4, s[12:15], s50 offen sc1
    s_add_u32 s50, s50, 4096
    s_waitcnt vmcnt(62)
    buffer_load_dwordx4 v[124:127], v4, s[12:15], s50 offen sc1
    s_add_u32 s50, s50, 4096
    s_waitcnt vmcnt(62)
    buffer_load_dwordx4 v[128:131], v4, s[12:15], s50 offen sc1
    s_add_u32 s50, s50, 4096
    s_waitcnt vmcnt(62)
    buffer_load_dwordx4 v[132:135], v4, s[12:15], s50 offen sc1
    s_and_b32 s50, s2, 0xe0
    s_mul_i32 s50, s50, 3
    s_add_u32 s50, s50, s2
    s_mul_i32 s50, s50, 49152
    s_add_u32 s50, s50, 3145728
    s_waitcnt vmcnt(62)
    buffer_load_dwordx4 a[96:99], v2, s[4:7], s50 offen offset:0 nt
    s_waitcnt vmcnt(62)
    buffer_load_dwordx4 a[100:103], v2, s[4:7], s50 offen offset:128 nt
    s_waitcnt vmcnt(62)
    buffer_load_dwordx4 a[104:107], v2, s[4:7], s50 offen offset:256 nt
    s_waitcnt vmcnt(62)
    buffer_load_dwordx4 a[108:111], v2, s[4:7], s50 offen offset:384 nt
    s_waitcnt vmcnt(62)
    buffer_load_dwordx4 a[112:115], v2, s[4:7], s50 offen offset:512 nt
    s_waitcnt vmcnt(62)
    buffer_load_dwordx4 a[116:119], v2, s[4:7], s50 offen offset:640 nt
    s_waitcnt vmcnt(62)
    buffer_load_dwordx4 a[120:123], v2, s[4:7], s50 offen offset:768 nt
    s_waitcnt vmcnt(62)
    buffer_load_dwordx4 a[124:127], v2, s[4:7], s50 offen offset:896 nt
    s_waitcnt vmcnt(62)
    buffer_load_dwordx4 a[128:131], v2, s[4:7], s50 offen offset:1024 nt
    s_waitcnt vmcnt(62)
    buffer_load_dwordx4 a[132:135], v2, s[4:7], s50 offen offset:1152 nt
    s_waitcnt vmcnt(62)
    buffer_load_dwordx4 a[136:139], v2, s[4:7], s50 offen offset:1280 nt
    s_waitcnt vmcnt(62)
    buffer_load_dwordx4 a[140:143], v2, s[4:7], s50 offen offset:1408 nt
    s_and_b32 s50, s2, 0xe0
    s_mul_i32 s50, s50, 3
    s_add_u32 s50, s50, s2
    s_mul_i32 s50, s50, 49152
    s_add_u32 s50, s50, 4718592
    s_waitcnt vmcnt(62)
    buffer_load_dwordx4 a[144:147], v2, s[4:7], s50 offen offset:0 nt
    s_waitcnt vmcnt(62)
    buffer_load_dwordx4 a[148:151], v2, s[4:7], s50 offen offset:128 nt
    s_waitcnt vmcnt(62)
    buffer_load_dwordx4 a[152:155], v2, s[4:7], s50 offen offset:256 nt
    s_waitcnt vmcnt(62)
    buffer_load_dwordx4 a[156:159], v2, s[4:7], s50 offen offset:384 nt
    s_waitcnt vmcnt(62)
    buffer_load_dwordx4 a[160:163], v2, s[4:7], s50 offen offset:512 nt
    s_waitcnt vmcnt(62)
    buffer_load_dwordx4 a[164:167], v2, s[4:7], s50 offen offset:640 nt
    s_waitcnt vmcnt(62)
    buffer_load_dwordx4 a[168:171], v2, s[4:7], s50 offen offset:768 nt
    s_waitcnt vmcnt(62)
    buffer_load_dwordx4 a[172:175], v2, s[4:7], s50 offen offset:896 nt
    s_waitcnt vmcnt(62)
    buffer_load_dwordx4 a[176:179], v2, s[4:7], s50 offen offset:1024 nt
    s_waitcnt vmcnt(62)
    buffer_load_dwordx4 a[180:183], v2, s[4:7], s50 offen offset:1152 nt
    s_waitcnt vmcnt(62)
    buffer_load_dwordx4 a[184:187], v2, s[4:7], s50 offen offset:1280 nt
    s_waitcnt vmcnt(62)
    buffer_load_dwordx4 a[188:191], v2, s[4:7], s50 offen offset:1408 nt
    s_waitcnt vmcnt(24)
L_z2_9:
    v_readfirstlane_b32 s57, v25
    s_nop 0
    s_mul_i32 s57, s57, 0x9e3779b1
    s_add_u32 s57, s57, 0x7f4a7c15
L_qchk_10:
    v_bitop3_b32 v69, v90, v94, s57 bitop3:0x7e
    v_bitop3_b32 v70, v98, v102, s57 bitop3:0x7e
    v_bitop3_b32 v71, v106, v110, s57 bitop3:0x7e
    v_or3_b32 v69, v69, v70, v71
    v_bitop3_b32 v70, v114, v118, s57 bitop3:0x7e
    v_bitop3_b32 v71, v122, v126, s57 bitop3:0x7e
    v_or3_b32 v69, v69, v70, v71
    v_bitop3_b32 v70, v130, v134, s57 bitop3:0x7e
    v_or_b32 v69, v69, v70
    v_cmp_ne_u32 s[76:77], 0, v69
    s_nop 0
    s_cmp_lg_u64 s[76:77], 0
    s_nop 1
    s_cbranch_scc0 L_qdone_11
    s_sleep 2
    s_waitcnt vmcnt(32)
    v_lshlrev_b32 v4, 4, v0
    s_mov_b32 s50, 4096
    buffer_load_dwordx4 v[88:91], v4, s[12:15], s50 offen sc1
    s_add_u32 s50, s50, 4096
    buffer_load_dwordx4 v[92:95], v4, s[12:15], s50 offen sc1
    s_add_u32 s50, s50, 4096
    buffer_load_dwordx4 v[96:99], v4, s[12:15], s50 offen sc1
    s_add_u32 s50, s50, 4096
    buffer_load_dwordx4 v[100:103], v4, s[12:15], s50 offen sc1
    s_add_u32 s50, s50, 4096
    buffer_load_dwordx4 v[104:107], v4, s[12:15], s50 offen sc1
    s_add_u32 s50, s50, 4096
    buffer_load_dwordx4 v[108:111], v4, s[12:15], s50 offen sc1
    s_add_u32 s50, s50, 4096
    buffer_load_dwordx4 v[112:115], v4, s[12:15], s50 offen sc1
    s_add_u32 s50, s50, 4096
    buffer_load_dwordx4 v[116:119], v4, s[12:15], s50 offen sc1
    s_add_u32 s50, s50, 4096
    buffer_load_dwordx4 v[120:123], v4, s[12:15], s50 offen sc1
    s_add_u32 s50, s50, 4096
    buffer_load_dwordx4 v[124:127], v4, s[12:15], s50 offen sc1
    s_add_u32 s50, s50, 4096
    buffer_load_dwordx4 v[128:131], v4, s[12:15], s50 offen sc1
    s_add_u32 s50, s50, 4096
    buffer_load_dwordx4 v[132:135], v4, s[12:15], s50 offen sc1
    s_waitcnt vmcnt(0)
    s_add_u32 s60, s60, 1
    s_cmp_lt_u32 s60, 131072
    s_cbranch_scc1 L_qchk_10
    v_mov_b32 v68, 64
    buffer_atomic_add v26, v68, s[40:43], 0 offen sc1
L_qdone_11:
    v_lshlrev_b32 v68, 3, v0
    ds_write_b64 v68, v[88:89] offset:0
    ds_write_b64 v68, v[92:93] offset:2048
    ds_write_b64 v68, v[96:97] offset:4096
    ds_write_b64 v68, v[100:101] offset:6144
    ds_write_b64 v68, v[104:105] offset:8192
    ds_write_b64 v68, v[108:109] offset:10240
    ds_write_b64 v68, v[112:113] offset:12288
    ds_write_b64 v68, v[116:117] offset:14336
    ds_write_b64 v68, v[120:121] offset:16384
    ds_write_b64 v68, v[124:125] offset:18432
    ds_write_b64 v68, v[128:129] offset:20480
    ds_write_b64 v68, v[132:133] offset:22528
    s_waitcnt lgkmcnt(0)
    s_barrier
    s_mov_b32 s58, 0
    s_mov_b32 s59, 0
    s_mov_b32 s56, 0x100000
    s_mov_b32 s86, 0x200000
    s_cmp_lt_u32 s2, 220
    s_cselect_b32 s86, 8192, s86
    s_cmp_lt_u32 s2, 200
    s_cselect_b32 s86, 8192, s86
    s_cmp_lt_u32 s2, 176
    s_cselect_b32 s86, 7552, s86
    s_cmp_lt_u32 s2, 156
    s_cselect_b32 s86, 7552, s86
    s_cmp_lt_u32 s2, 96
    s_cselect_b32 s86, 2097152, s86
    s_mov_b32 s63, 6258688
    s_lshr_b32 s61, s2, 3
    s_add_u32 s61, s61, s2
    s_mov_b32 s82, 0
    s_mov_b32 s83, 0
    s_lshl_b32 s50, s48, 3
    v_mov_b32 v15, s50
    v_subrev_u32 v108, 34560, v19
    v_subrev_u32 v109, 34560, v20
    v_and_b32 v24, 0x1ff, v17
    v_add_u32 v110, 55040, v21
    v_mov_b32 v113, 0
    s_cmp_eq_u32 s39, 0
    s_cselect_b32 s50, 0x1000, 0
    v_mov_b32 v112, s50
    s_and_b32 s49, s2, 0xe0
    s_mul_i32 s49, s49, 3
    s_add_u32 s49, s49, s2
    s_mov_b32 s3, 0
    s_sub_u32 s50, s2, 96
    s_cmp_lt_u32 s50, 80
    s_cbranch_scc1 L_kloop_15
    s_sub_u32 s50, s2, 176
    s_cmp_lt_u32 s50, 44
    s_cbranch_scc1 L_kloop_16
    s_mov_b32 s87, 0
.p2align 6
L_kloop_14:
    s_lshr_b32 s50, 0x14, s3
    s_and_b32 s50, s50, 1
    s_cbranch_scc1 L_hook_19
L_back_21:
    s_lshr_b32 s62, s49, 7
    s_mul_i32 s62, s62, 384
    v_mad_u32_u24 v68, v5, s62, v6
    v_mad_u32_u24 v69, v7, s62, v8
    ds_read_b128 v[28:31], v68 offset:0
    ds_read_b128 v[32:35], v68 offset:128
    ds_read_b128 v[36:39], v68 offset:256
    ds_read_b128 v[40:43], v69 offset:0
    ds_read_b128 v[44:47], v69 offset:128
    ds_read_b128 v[48:51], v69 offset:256
    s_waitcnt vmcnt(46) lgkmcnt(0)
    v_mfma_f32_16x16x32_bf16 v[52:55], a[0:3], v[28:31], 0
    v_mfma_f32_16x16x32_bf16 v[56:59], a[12:15], v[28:31], 0
    v_mfma_f32_16x16x32_bf16 v[52:55], a[4:7], v[32:35], v[52:55]
    v_mfma_f32_16x16x32_bf16 v[56:59], a[16:19], v[32:35], v[56:59]
    v_mfma_f32_16x16x32_bf16 v[52:55], a[8:11], v[36:39], v[52:55]
    v_mfma_f32_16x16x32_bf16 v[56:59], a[20:23], v[36:39], v[56:59]
    s_waitcnt vmcnt(40)
    v_mfma_f32_16x16x32_bf16 v[52:55], a[24:27], v[40:43], v[52:55]
    v_mfma_f32_16x16x32_bf16 v[56:59], a[36:39], v[40:43], v[56:59]
    v_mfma_f32_16x16x32_bf16 v[52:55], a[28:31], v[44:47], v[52:55]
    v_mfma_f32_16x16x32_bf16 v[56:59], a[40:43], v[44:47], v[56:59]
    v_mfma_f32_16x16x32_bf16 v[52:55], a[32:35], v[48:51], v[52:55]
    v_mfma_f32_16x16x32_bf16 v[56:59], a[44:47], v[48:51], v[56:59]
    s_add_u32 s50, s49, 1024
    s_mul_i32 s50, s50, 49152
    s_waitcnt vmcnt(4)
    buffer_load_dwordx4 a[0:3], v2, s[4:7], s50 offen offset:0 nt
    s_waitcnt vmcnt(4)
    buffer_load_dwordx4 a[4:7], v2, s[4:7], s50 offen offset:128 nt
    s_waitcnt vmcnt(4)
    buffer_load_dwordx4 a[8:11], v2, s[4:7], s50 offen offset:256 nt
    s_waitcnt vmcnt(4)
    buffer_load_dwordx4 a[12:15], v2, s[4:7], s50 offen offset:384 nt
    s_waitcnt vmcnt(4)
    buffer_load_dwordx4 a[16:19], v2, s[4:7], s50 offen offset:512 nt
    s_waitcnt vmcnt(4)
    buffer_load_dwordx4 a[20:23], v2, s[4:7], s50 offen offset:640 nt
    s_waitcnt vmcnt(4)
    buffer_load_dwordx4 a[24:27], v2, s[4:7], s50 offen offset:768 nt
    s_waitcnt vmcnt(4)
    buffer_load_dwordx4 a[28:31], v2, s[4:7], s50 offen offset:896 nt
    s_waitcnt vmcnt(4)
    buffer_load_dwordx4 a[32:35], v2, s[4:7], s50 offen offset:1024 nt
    s_waitcnt vmcnt(4)
    buffer_load_dwordx4 a[36:39], v2, s[4:7], s50 offen offset:1152 nt
    buffer_load_dwordx4 a[40:43], v2, s[4:7], s50 offen offset:1280 nt
    buffer_load_dwordx4 a[44:47], v2, s[4:7], s50 offen offset:1408 nt
    s_add_u32 s50, s49, 1056
    s_mul_i32 s50, s50, 49152
    buffer_load_dword v25, v16, s[4:7], s50 offen nt
    v_add_f32_dpp v68, v53, v52 quad_perm:[1,1,1,1] row_mask:0xf bank_mask:0xf
    v_add_f32_dpp v69, v55, v54 quad_perm:[3,3,3,3] row_mask:0xf bank_mask:0xf
    v_add_f32_dpp v70, v56, v57 quad_perm:[0,0,0,0] row_mask:0xf bank_mask:0xf
    v_add_f32_dpp v71, v58, v59 quad_perm:[2,2,2,2] row_mask:0xf bank_mask:0xf
    v_cndmask_b32 v68, v68, v70, s[64:65]
    v_cndmask_b32 v69, v69, v71, s[64:65]
    s_nop 1
    v_add_f32_dpp v68, v69, v68 quad_perm:[2,3,2,3] row_mask:0xf bank_mask:0xf
    s_nop 1
    v_mov_b32_dpp v69, v68 quad_perm:[0,1,0,1] row_mask:0xf bank_mask:0xf
    v_cvt_pk_bf16_f32 v69, v69, v69
    v_and_b32 v69, 0xffff0000, v69
    v_mul_f32 v69, 0x3d93cd3a, v69
    v_cvt_pk_bf16_f32 v76, v69, v69
    v_and_b32 v76, 0xffff0000, v76
    ds_write_b16_d16_hi v13, v76 offset:0
    s_waitcnt vmcnt(46)
    v_mfma_f32_16x16x32_bf16 v[52:55], a[48:51], v[28:31], 0
    v_mfma_f32_16x16x32_bf16 v[56:59], a[60:63], v[28:31], 0
    v_mfma_f32_16x16x32_bf16 v[52:55], a[52:55], v[32:35], v[52:55]
    v_mfma_f32_16x16x32_bf16 v[56:59], a[64:67], v[32:35], v[56:59]
    v_mfma_f32_16x16x32_bf16 v[52:55], a[56:59], v[36:39], v[52:55]
    v_mfma_f32_16x16x32_bf16 v[56:59], a[68:71], v[36:39], v[56:59]
    s_waitcnt vmcnt(40)
    v_mfma_f32_16x16x32_bf16 v[52:55], a[72:75], v[40:43], v[52:55]
    v_mfma_f32_16x16x32_bf16 v[56:59], a[84:87], v[40:43], v[56:59]
    v_mfma_f32_16x16x32_bf16 v[52:55], a[76:79], v[44:47], v[52:55]
    v_mfma_f32_16x16x32_bf16 v[56:59], a[88:91], v[44:47], v[56:59]
    v_mfma_f32_16x16x32_bf16 v[52:55], a[80:83], v[48:51], v[52:55]
    v_mfma_f32_16x16x32_bf16 v[56:59], a[92:95], v[48:51], v[56:59]
    s_add_u32 s50, s49, 1056
    s_mul_i32 s50, s50, 49152
    s_waitcnt vmcnt(5)
    buffer_load_dwordx4 a[48:51], v2, s[4:7], s50 offen offset:0 nt
    s_waitcnt vmcnt(5)
    buffer_load_dwordx4 a[52:55], v2, s[4:7], s50 offen offset:128 nt
    s_waitcnt vmcnt(5)
    buffer_load_dwordx4 a[56:59], v2, s[4:7], s50 offen offset:256 nt
    s_waitcnt vmcnt(5)
    buffer_load_dwordx4 a[60:63], v2, s[4:7], s50 offen offset:384 nt
    s_waitcnt vmcnt(5)
    buffer_load_dwordx4 a[64:67], v2, s[4:7], s50 offen offset:512 nt
    s_waitcnt vmcnt(4)
    buffer_load_dwordx4 a[68:71], v2, s[4:7], s50 offen offset:640 nt
    s_waitcnt vmcnt(4)
    buffer_load_dwordx4 a[72:75], v2, s[4:7], s50 offen offset:768 nt
    s_waitcnt vmcnt(4)
    buffer_load_dwordx4 a[76:79], v2, s[4:7], s50 offen offset:896 nt
    s_waitcnt vmcnt(4)
    buffer_load_dwordx4 a[80:83], v2, s[4:7], s50 offen offset:1024 nt
    s_waitcnt vmcnt(4)
    buffer_load_dwordx4 a[84:87], v2, s[4:7], s50 offen offset:1152 nt
    buffer_load_dwordx4 a[88:91], v2, s[4:7], s50 offen offset:1280 nt
    buffer_load_dwordx4 a[92:95], v2, s[4:7], s50 offen offset:1408 nt
    s_add_u32 s50, s49, 1088
    s_mul_i32 s50, s50, 49152
    buffer_load_dword v25, v16, s[4:7], s50 offen nt
    v_add_f32_dpp v68, v53, v52 quad_perm:[1,1,1,1] row_mask:0xf bank_mask:0xf
    v_add_f32_dpp v69, v55, v54 quad_perm:[3,3,3,3] row_mask:0xf bank_mask:0xf
    v_add_f32_dpp v70, v56, v57 quad_perm:[0,0,0,0] row_mask:0xf bank_mask:0xf
    v_add_f32_dpp v71, v58, v59 quad_perm:[2,2,2,2] row_mask:0xf bank_mask:0xf
    v_cndmask_b32 v68, v68, v70, s[64:65]
    v_cndmask_b32 v69, v69, v71, s[64:65]
    s_nop 1
    v_add_f32_dpp v68, v69, v68 quad_perm:[2,3,2,3] row_mask:0xf bank_mask:0xf
    s_nop 1
    v_mov_b32_dpp v69, v68 quad_perm:[0,1,0,1] row_mask:0xf bank_mask:0xf
    v_cvt_pk_bf16_f32 v69, v69, v69
    v_and_b32 v69, 0xffff0000, v69
    v_mul_f32 v69, 0x3d93cd3a, v69
    v_cvt_pk_bf16_f32 v77, v69, v69
    v_and_b32 v77, 0xffff0000, v77
    ds_write_b16_d16_hi v13, v77 offset:256
    s_waitcnt vmcnt(44)
    v_mfma_f32_16x16x32_bf16 v[52:55], a[96:99], v[28:31], 0
    v_mfma_f32_16x16x32_bf16 v[56:59], a[108:111], v[28:31], 0
    v_mfma_f32_16x16x32_bf16 v[52:55], a[100:103], v[32:35], v[52:55]
    v_mfma_f32_16x16x32_bf16 v[56:59], a[112:115], v[32:35], v[56:59]
    v_mfma_f32_16x16x32_bf16 v[52:55], a[104:107], v[36:39], v[52:55]
    v_mfma_f32_16x16x32_bf16 v[56:59], a[116:119], v[36:39], v[56:59]
    s_waitcnt vmcnt(38)
    v_mfma_f32_16x16x32_bf16 v[52:55], a[120:123], v[40:43], v[52:55]
    v_mfma_f32_16x16x32_bf16 v[56:59], a[132:135], v[40:43], v[56:59]
    v_mfma_f32_16x16x32_bf16 v[52:55], a[124:127], v[44:47], v[52:55]
    v_mfma_f32_16x16x32_bf16 v[56:59], a[136:139], v[44:47], v[56:59]
    v_mfma_f32_16x16x32_bf16 v[52:55], a[128:131], v[48:51], v[52:55]
    v_mfma_f32_16x16x32_bf16 v[56:59], a[140:143], v[48:51], v[56:59]
    s_add_u32 s50, s49, 1088
    s_mul_i32 s50, s50, 49152
    s_waitcnt vmcnt(5)
    buffer_load_dwordx4 a[96:99], v2, s[4:7], s50 offen offset:0 nt
    s_waitcnt vmcnt(5)
    buffer_load_dwordx4 a[100:103], v2, s[4:7], s50 offen offset:128 nt
    s_waitcnt vmcnt(5)
    buffer_load_dwordx4 a[104:107], v2, s[4:7], s50 offen offset:256 nt
    s_waitcnt vmcnt(5)
    buffer_load_dwordx4 a[108:111], v2, s[4:7], s50 offen offset:384 nt
    s_waitcnt vmcnt(5)
    buffer_load_dwordx4 a[112:115], v2, s[4:7], s50 offen offset:512 nt
    s_waitcnt vmcnt(4)
    buffer_load_dwordx4 a[116:119], v2, s[4:7], s50 offen offset:640 nt
    s_waitcnt vmcnt(4)
    buffer_load_dwordx4 a[120:123], v2, s[4:7], s50 offen offset:768 nt
    s_waitcnt vmcnt(4)
    buffer_load_dwordx4 a[124:127], v2, s[4:7], s50 offen offset:896 nt
    s_waitcnt vmcnt(4)
    buffer_load_dwordx4 a[128:131], v2, s[4:7], s50 offen offset:1024 nt
    s_waitcnt vmcnt(4)
    buffer_load_dwordx4 a[132:135], v2, s[4:7], s50 offen offset:1152 nt
    buffer_load_dwordx4 a[136:139], v2, s[4:7], s50 offen offset:1280 nt
    buffer_load_dwordx4 a[140:143], v2, s[4:7], s50 offen offset:1408 nt
    s_add_u32 s50, s49, 1120
    s_mul_i32 s50, s50, 49152
    buffer_load_dword v25, v16, s[4:7], s50 offen nt
    v_add_f32_dpp v68, v53, v52 quad_perm:[1,1,1,1] row_mask:0xf bank_mask:0xf
    v_add_f32_dpp v69, v55, v54 quad_perm:[3,3,3,3] row_mask:0xf bank_mask:0xf
    v_add_f32_dpp v70, v56, v57 quad_perm:[0,0,0,0] row_mask:0xf bank_mask:0xf
    v_add_f32_dpp v71, v58, v59 quad_perm:[2,2,2,2] row_mask:0xf bank_mask:0xf
    v_cndmask_b32 v68, v68, v70, s[64:65]
    v_cndmask_b32 v69, v69, v71, s[64:65]
    s_nop 1
    v_add_f32_dpp v68, v69, v68 quad_perm:[2,3,2,3] row_mask:0xf bank_mask:0xf
    s_nop 1
    v_mov_b32_dpp v69, v68 quad_perm:[0,1,0,1] row_mask:0xf bank_mask:0xf
    v_cvt_pk_bf16_f32 v69, v69, v69
    v_and_b32 v69, 0xffff0000, v69
    v_mul_f32 v69, 0x3d93cd3a, v69
    v_cvt_pk_bf16_f32 v78, v69, v69
    v_and_b32 v78, 0xffff0000, v78
    ds_write_b16_d16_hi v13, v78 offset:512
    s_waitcnt vmcnt(45)
    v_mfma_f32_16x16x32_bf16 v[52:55], a[144:147], v[28:31], 0
    v_mfma_f32_16x16x32_bf16 v[56:59], a[156:159], v[28:31], 0
    v_mfma_f32_16x16x32_bf16 v[52:55], a[148:151], v[32:35], v[52:55]
    v_mfma_f32_16x16x32_bf16 v[56:59], a[160:163], v[32:35], v[56:59]
    v_mfma_f32_16x16x32_bf16 v[52:55], a[152:155], v[36:39], v[52:55]
    v_mfma_f32_16x16x32_bf16 v[56:59], a[164:167], v[36:39], v[56:59]
    s_waitcnt vmcnt(39)
    v_mfma_f32_16x16x32_bf16 v[52:55], a[168:171], v[40:43], v[52:55]
    v_mfma_f32_16x16x32_bf16 v[56:59], a[180:183], v[40:43], v[56:59]
    v_mfma_f32_16x16x32_bf16 v[52:55], a[172:175], v[44:47], v[52:55]
    v_mfma_f32_16x16x32_bf16 v[56:59], a[184:187], v[44:47], v[56:59]
    v_mfma_f32_16x16x32_bf16 v[52:55], a[176:179], v[48:51], v[52:55]
    v_mfma_f32_16x16x32_bf16 v[56:59], a[188:191], v[48:51], v[56:59]
    s_add_u32 s50, s49, 1120
    s_mul_i32 s50, s50, 49152
    s_waitcnt vmcnt(5)
    buffer_load_dwordx4 a[144:147], v2, s[4:7], s50 offen offset:0 nt
    s_waitcnt vmcnt(5)
    buffer_load_dwordx4 a[148:151], v2, s[4:7], s50 offen offset:128 nt
    s_waitcnt vmcnt(5)
    buffer_load_dwordx4 a[152:155], v2, s[4:7], s50 offen offset:256 nt
    s_waitcnt vmcnt(5)
    buffer_load_dwordx4 a[156:159], v2, s[4:7], s50 offen offset:384 nt
    s_waitcnt vmcnt(5)
    buffer_load_dwordx4 a[160:163], v2, s[4:7], s50 offen offset:512 nt
    s_waitcnt vmcnt(4)
    buffer_load_dwordx4 a[164:167], v2, s[4:7], s50 offen offset:640 nt
    s_waitcnt vmcnt(4)
    buffer_load_dwordx4 a[168:171], v2, s[4:7], s50 offen offset:768 nt
    s_waitcnt vmcnt(4)
    buffer_load_dwordx4 a[172:175], v2, s[4:7], s50 offen offset:896 nt
    s_waitcnt vmcnt(4)
    buffer_load_dwordx4 a[176:179], v2, s[4:7], s50 offen offset:1024 nt
    buffer_load_dwordx4 a[180:183], v2, s[4:7], s50 offen offset:1152 nt
    buffer_load_dwordx4 a[184:187], v2, s[4:7], s50 offen offset:1280 nt
    buffer_load_dwordx4 a[188:191], v2, s[4:7], s50 offen offset:1408 nt
    s_add_u32 s50, s49, 2048
    s_mul_i32 s50, s50, 49152
    buffer_load_dword v25, v16, s[4:7], s50 offen nt
    v_add_f32_dpp v68, v53, v52 quad_perm:[1,1,1,1] row_mask:0xf bank_mask:0xf
    v_add_f32_dpp v69, v55, v54 quad_perm:[3,3,3,3] row_mask:0xf bank_mask:0xf
    v_add_f32_dpp v70, v56, v57 quad_perm:[0,0,0,0] row_mask:0xf bank_mask:0xf
    v_add_f32_dpp v71, v58, v59 quad_perm:[2,2,2,2] row_mask:0xf bank_mask:0xf
    v_cndmask_b32 v68, v68, v70, s[64:65]
    v_cndmask_b32 v69, v69, v71, s[64:65]
    s_nop 1
    v_add_f32_dpp v68, v69, v68 quad_perm:[2,3,2,3] row_mask:0xf bank_mask:0xf
    s_nop 1
    v_mov_b32_dpp v69, v68 quad_perm:[0,1,0,1] row_mask:0xf bank_mask:0xf
    v_cvt_pk_bf16_f32 v69, v69, v69
    v_and_b32 v69, 0xffff0000, v69
    v_mul_f32 v69, 0x3d93cd3a, v69
    v_cvt_pk_bf16_f32 v79, v69, v69
    v_and_b32 v79, 0xffff0000, v79
    ds_write_b16_d16_hi v13, v79 offset:768
    v_max3_f32 v70, v76, v77, v78
    v_max_f32 v70, v70, v79
    s_nop 1
    v_max_f32_dpp v70, v70, v70 quad_perm:[1,0,3,2] row_mask:0xf bank_mask:0xf
    s_nop 1
    v_max_f32_dpp v70, v70, v70 row_half_mirror row_mask:0xf bank_mask:0xf
    s_nop 1
    v_max_f32_dpp v70, v70, v70 row_mirror row_mask:0xf bank_mask:0xf
    s_nop 1
    v_max_f32_dpp v70, v70, v70 row_bcast:15 row_mask:0xa bank_mask:0xf
    s_nop 1
    v_max_f32_dpp v70, v70, v70 row_bcast:31 row_mask:0xc bank_mask:0xf
    s_nop 0
    v_readlane_b32 s54, v70, 63
    s_nop 1
    v_subrev_f32 v76, s54, v76
    v_subrev_f32 v77, s54, v77
    v_subrev_f32 v78, s54, v78
    v_subrev_f32 v79, s54, v79
    v_mul_f32 v76, 0x3fb8aa3b, v76
    v_mul_f32 v77, 0x3fb8aa3b, v77
    v_mul_f32 v78, 0x3fb8aa3b, v78
    v_mul_f32 v79, 0x3fb8aa3b, v79
    v_exp_f32 v76, v76
    v_exp_f32 v77, v77
    v_exp_f32 v78, v78
    v_exp_f32 v79, v79
    v_add_f32 v76, v76, v77
    v_add_f32 v78, v78, v79
    v_add_f32 v71, v76, v78
    s_nop 1
    v_add_f32_dpp v71, v71, v71 quad_perm:[1,0,3,2] row_mask:0xf bank_mask:0xf
    s_nop 1
    v_add_f32_dpp v71, v71, v71 row_half_mirror row_mask:0xf bank_mask:0xf
    s_nop 1
    v_add_f32_dpp v71, v71, v71 row_mirror row_mask:0xf bank_mask:0xf
    s_nop 1
    v_add_f32_dpp v71, v71, v71 row_bcast:15 row_mask:0xa bank_mask:0xf
    s_nop 1
    v_add_f32_dpp v71, v71, v71 row_bcast:31 row_mask:0xc bank_mask:0xf
    s_mov_b64 exec, s[68:69]
    ds_write_b64 v15, v[70:71] offset:33280
    s_mov_b64 exec, -1
    v_add_u32 v13, 1024, v13
    v_add_u32 v15, 32, v15
    s_add_u32 s49, s49, 1024
    s_add_u32 s3, s3, 1
    s_cmp_lt_u32 s3, 7
    s_cbranch_scc1 L_kloop_14
    s_branch L_kend_13
.p2align 6
L_kloop_15:
    s_lshr_b32 s50, 0x14, s3
    s_and_b32 s50, s50, 1
    s_cbranch_scc1 L_hook_19
L_back_22:
    s_lshr_b32 s62, s49, 7
    s_mul_i32 s62, s62, 384
    v_mad_u32_u24 v68, v5, s62, v6
    v_mad_u32_u24 v69, v7, s62, v8
    ds_read_b128 v[28:31], v68 offset:0
    ds_read_b128 v[32:35], v68 offset:128
    ds_read_b128 v[36:39], v68 offset:256
    ds_read_b128 v[40:43], v69 offset:0
    ds_read_b128 v[44:47], v69 offset:128
    ds_read_b128 v[48:51], v69 offset:256
    s_waitcnt vmcnt(46) lgkmcnt(0)
    v_mfma_f32_16x16x32_bf16 v[52:55], a[0:3], v[28:31], 0
    v_mfma_f32_16x16x32_bf16 v[56:59], a[12:15], v[28:31], 0
    v_mfma_f32_16x16x32_bf16 v[52:55], a[4:7], v[32:35], v[52:55]
    v_mfma_f32_16x16x32_bf16 v[56:59], a[16:19], v[32:35], v[56:59]
    v_mfma_f32_16x16x32_bf16 v[52:55], a[8:11], v[36:39], v[52:55]
    v_mfma_f32_16x16x32_bf16 v[56:59], a[20:23], v[36:39], v[56:59]
    s_waitcnt vmcnt(40)
    v_mfma_f32_16x16x32_bf16 v[52:55], a[24:27], v[40:43], v[52:55]
    v_mfma_f32_16x16x32_bf16 v[56:59], a[36:39], v[40:43], v[56:59]
    v_mfma_f32_16x16x32_bf16 v[52:55], a[28:31], v[44:47], v[52:55]
    v_mfma_f32_16x16x32_bf16 v[56:59], a[40:43], v[44:47], v[56:59]
    v_mfma_f32_16x16x32_bf16 v[52:55], a[32:35], v[48:51], v[52:55]
    v_mfma_f32_16x16x32_bf16 v[56:59], a[44:47], v[48:51], v[56:59]
    s_add_u32 s50, s49, 1024
    s_mul_i32 s50, s50, 49152
    s_waitcnt vmcnt(5)
    buffer_load_dwordx4 a[0:3], v2, s[4:7], s50 offen offset:0 nt
    s_waitcnt vmcnt(5)
    buffer_load_dwordx4 a[4:7], v2, s[4:7], s50 offen offset:128 nt
    s_waitcnt vmcnt(5)
    buffer_load_dwordx4 a[8:11], v2, s[4:7], s50 offen offset:256 nt
    s_waitcnt vmcnt(5)
    buffer_load_dwordx4 a[12:15], v2, s[4:7], s50 offen offset:384 nt
    s_waitcnt vmcnt(5)
    buffer_load_dwordx4 a[16:19], v2, s[4:7], s50 offen offset:512 nt
    s_waitcnt vmcnt(5)
    buffer_load_dwordx4 a[20:23], v2, s[4:7], s50 offen offset:640 nt
    s_waitcnt vmcnt(5)
    buffer_load_dwordx4 a[24:27], v2, s[4:7], s50 offen offset:768 nt
    s_waitcnt vmcnt(5)
    buffer_load_dwordx4 a[28:31], v2, s[4:7], s50 offen offset:896 nt
    s_waitcnt vmcnt(5)
    buffer_load_dwordx4 a[32:35], v2, s[4:7], s50 offen offset:1024 nt
    s_waitcnt vmcnt(5)
    buffer_load_dwordx4 a[36:39], v2, s[4:7], s50 offen offset:1152 nt
    buffer_load_dwordx4 a[40:43], v2, s[4:7], s50 offen offset:1280 nt
    buffer_load_dwordx4 a[44:47], v2, s[4:7], s50 offen offset:1408 nt
    s_add_u32 s50, s49, 1056
    s_mul_i32 s50, s50, 49152
    buffer_load_dword v25, v16, s[4:7], s50 offen nt
    v_add_f32_dpp v68, v53, v52 quad_perm:[1,1,1,1] row_mask:0xf bank_mask:0xf
    v_add_f32_dpp v69, v55, v54 quad_perm:[3,3,3,3] row_mask:0xf bank_mask:0xf
    v_add_f32_dpp v70, v56, v57 quad_perm:[0,0,0,0] row_mask:0xf bank_mask:0xf
    v_add_f32_dpp v71, v58, v59 quad_perm:[2,2,2,2] row_mask:0xf bank_mask:0xf
    v_cndmask_b32 v68, v68, v70, s[64:65]
    v_cndmask_b32 v69, v69, v71, s[64:65]
    s_nop 1
    v_add_f32_dpp v68, v69, v68 quad_perm:[2,3,2,3] row_mask:0xf bank_mask:0xf
    s_nop 1
    v_mov_b32_dpp v69, v68 quad_perm:[0,1,0,1] row_mask:0xf bank_mask:0xf
    v_cvt_pk_bf16_f32 v69, v69, v69
    v_and_b32 v69, 0xffff0000, v69
    v_mul_f32 v69, 0x3d93cd3a, v69
    v_cvt_pk_bf16_f32 v76, v69, v69
    v_and_b32 v76, 0xffff0000, v76
    ds_write_b16_d16_hi v13, v76 offset:0
    s_waitcnt vmcnt(46)
    v_mfma_f32_16x16x32_bf16 v[52:55], a[48:51], v[28:31], 0
    v_mfma_f32_16x16x32_bf16 v[56:59], a[60:63], v[28:31], 0
    v_mfma_f32_16x16x32_bf16 v[52:55], a[52:55], v[32:35], v[52:55]
    v_mfma_f32_16x16x32_bf16 v[56:59], a[64:67], v[32:35], v[56:59]
    v_mfma_f32_16x16x32_bf16 v[52:55], a[56:59], v[36:39], v[52:55]
    v_mfma_f32_16x16x32_bf16 v[56:59], a[68:71], v[36:39], v[56:59]
    s_waitcnt vmcnt(40)
    v_mfma_f32_16x16x32_bf16 v[52:55], a[72:75], v[40:43], v[52:55]
    v_mfma_f32_16x16x32_bf16 v[56:59], a[84:87], v[40:43], v[56:59]
    v_mfma_f32_16x16x32_bf16 v[52:55], a[76:79], v[44:47], v[52:55]
    v_mfma_f32_16x16x32_bf16 v[56:59], a[88:91], v[44:47], v[56:59]
    v_mfma_f32_16x16x32_bf16 v[52:55], a[80:83], v[48:51], v[52:55]
    v_mfma_f32_16x16x32_bf16 v[56:59], a[92:95], v[48:51], v[56:59]
    s_add_u32 s50, s49, 1056
    s_mul_i32 s50, s50, 49152
    s_waitcnt vmcnt(6)
    buffer_load_dwordx4 a[48:51], v2, s[4:7], s50 offen offset:0 nt
    s_waitcnt vmcnt(6)
    buffer_load_dwordx4 a[52:55], v2, s[4:7], s50 offen offset:128 nt
    s_waitcnt vmcnt(6)
    buffer_load_dwordx4 a[56:59], v2, s[4:7], s50 offen offset:256 nt
    s_waitcnt vmcnt(6)
    buffer_load_dwordx4 a[60:63], v2, s[4:7], s50 offen offset:384 nt
    s_waitcnt vmcnt(6)
    buffer_load_dwordx4 a[64:67], v2, s[4:7], s50 offen offset:512 nt
    s_waitcnt vmcnt(6)
    buffer_load_dwordx4 a[68:71], v2, s[4:7], s50 offen offset:640 nt
    s_waitcnt vmcnt(5)
    buffer_load_dwordx4 a[72:75], v2, s[4:7], s50 offen offset:768 nt
    s_waitcnt vmcnt(5)
    buffer_load_dwordx4 a[76:79], v2, s[4:7], s50 offen offset:896 nt
    s_waitcnt vmcnt(5)
    buffer_load_dwordx4 a[80:83], v2, s[4:7], s50 offen offset:1024 nt
    s_waitcnt vmcnt(5)
    buffer_load_dwordx4 a[84:87], v2, s[4:7], s50 offen offset:1152 nt
    buffer_load_dwordx4 a[88:91], v2, s[4:7], s50 offen offset:1280 nt
    buffer_load_dwordx4 a[92:95], v2, s[4:7], s50 offen offset:1408 nt
    s_add_u32 s50, s49, 1088
    s_mul_i32 s50, s50, 49152
    buffer_load_dword v25, v16, s[4:7], s50 offen nt
    v_add_f32_dpp v68, v53, v52 quad_perm:[1,1,1,1] row_mask:0xf bank_mask:0xf
    v_add_f32_dpp v69, v55, v54 quad_perm:[3,3,3,3] row_mask:0xf bank_mask:0xf
    v_add_f32_dpp v70, v56, v57 quad_perm:[0,0,0,0] row_mask:0xf bank_mask:0xf
    v_add_f32_dpp v71, v58, v59 quad_perm:[2,2,2,2] row_mask:0xf bank_mask:0xf
    v_cndmask_b32 v68, v68, v70, s[64:65]
    v_cndmask_b32 v69, v69, v71, s[64:65]
    s_nop 1
    v_add_f32_dpp v68, v69, v68 quad_perm:[2,3,2,3] row_mask:0xf bank_mask:0xf
    s_nop 1
    v_mov_b32_dpp v69, v68 quad_perm:[0,1,0,1] row_mask:0xf bank_mask:0xf
    v_cvt_pk_bf16_f32 v69, v69, v69
    v_and_b32 v69, 0xffff0000, v69
    v_mul_f32 v69, 0x3d93cd3a, v69
    v_cvt_pk_bf16_f32 v77, v69, v69
    v_and_b32 v77, 0xffff0000, v77
    ds_write_b16_d16_hi v13, v77 offset:256
    s_waitcnt vmcnt(44)
    v_mfma_f32_16x16x32_bf16 v[52:55], a[96:99], v[28:31], 0
    v_mfma_f32_16x16x32_bf16 v[56:59], a[108:111], v[28:31], 0
    v_mfma_f32_16x16x32_bf16 v[52:55], a[100:103], v[32:35], v[52:55]
    v_mfma_f32_16x16x32_bf16 v[56:59], a[112:115], v[32:35], v[56:59]
    v_mfma_f32_16x16x32_bf16 v[52:55], a[104:107], v[36:39], v[52:55]
    v_mfma_f32_16x16x32_bf16 v[56:59], a[116:119], v[36:39], v[56:59]
    s_waitcnt vmcnt(38)
    v_mfma_f32_16x16x32_bf16 v[52:55], a[120:123], v[40:43], v[52:55]
    v_mfma_f32_16x16x32_bf16 v[56:59], a[132:135], v[40:43], v[56:59]
    v_mfma_f32_16x16x32_bf16 v[52:55], a[124:127], v[44:47], v[52:55]
    v_mfma_f32_16x16x32_bf16 v[56:59], a[136:139], v[44:47], v[56:59]
    v_mfma_f32_16x16x32_bf16 v[52:55], a[128:131], v[48:51], v[52:55]
    v_mfma_f32_16x16x32_bf16 v[56:59], a[140:143], v[48:51], v[56:59]
    s_add_u32 s50, s49, 1088
    s_mul_i32 s50, s50, 49152
    s_waitcnt vmcnt(6)
    buffer_load_dwordx4 a[96:99], v2, s[4:7], s50 offen offset:0 nt
    s_waitcnt vmcnt(6)
    buffer_load_dwordx4 a[100:103], v2, s[4:7], s50 offen offset:128 nt
    s_waitcnt vmcnt(6)
    buffer_load_dwordx4 a[104:107], v2, s[4:7], s50 offen offset:256 nt
    s_waitcnt vmcnt(6)
    buffer_load_dwordx4 a[108:111], v2, s[4:7], s50 offen offset:384 nt
    s_waitcnt vmcnt(6)
    buffer_load_dwordx4 a[112:115], v2, s[4:7], s50 offen offset:512 nt
    s_waitcnt vmcnt(6)
    buffer_load_dwordx4 a[116:119], v2, s[4:7], s50 offen offset:640 nt
    s_waitcnt vmcnt(5)
    buffer_load_dwordx4 a[120:123], v2, s[4:7], s50 offen offset:768 nt
    s_waitcnt vmcnt(5)
    buffer_load_dwordx4 a[124:127], v2, s[4:7], s50 offen offset:896 nt
    s_waitcnt vmcnt(5)
    buffer_load_dwordx4 a[128:131], v2, s[4:7], s50 offen offset:1024 nt
    s_waitcnt vmcnt(5)
    buffer_load_dwordx4 a[132:135], v2, s[4:7], s50 offen offset:1152 nt
    buffer_load_dwordx4 a[136:139], v2, s[4:7], s50 offen offset:1280 nt
    buffer_load_dwordx4 a[140:143], v2, s[4:7], s50 offen offset:1408 nt
    s_add_u32 s50, s49, 1120
    s_mul_i32 s50, s50, 49152
    buffer_load_dword v25, v16, s[4:7], s50 offen nt
    v_add_f32_dpp v68, v53, v52 quad_perm:[1,1,1,1] row_mask:0xf bank_mask:0xf
    v_add_f32_dpp v69, v55, v54 quad_perm:[3,3,3,3] row_mask:0xf bank_mask:0xf
    v_add_f32_dpp v70, v56, v57 quad_perm:[0,0,0,0] row_mask:0xf bank_mask:0xf
    v_add_f32_dpp v71, v58, v59 quad_perm:[2,2,2,2] row_mask:0xf bank_mask:0xf
    v_cndmask_b32 v68, v68, v70, s[64:65]
    v_cndmask_b32 v69, v69, v71, s[64:65]
    s_nop 1
    v_add_f32_dpp v68, v69, v68 quad_perm:[2,3,2,3] row_mask:0xf bank_mask:0xf
    s_nop 1
    v_mov_b32_dpp v69, v68 quad_perm:[0,1,0,1] row_mask:0xf bank_mask:0xf
    v_cvt_pk_bf16_f32 v69, v69, v69
    v_and_b32 v69, 0xffff0000, v69
    v_mul_f32 v69, 0x3d93cd3a, v69
    v_cvt_pk_bf16_f32 v78, v69, v69
    v_and_b32 v78, 0xffff0000, v78
    ds_write_b16_d16_hi v13, v78 offset:512
    s_waitcnt vmcnt(45)
    v_mfma_f32_16x16x32_bf16 v[52:55], a[144:147], v[28:31], 0
    v_mfma_f32_16x16x32_bf16 v[56:59], a[156:159], v[28:31], 0
    v_mfma_f32_16x16x32_bf16 v[52:55], a[148:151], v[32:35], v[52:55]
    v_mfma_f32_16x16x32_bf16 v[56:59], a[160:163], v[32:35], v[56:59]
    v_mfma_f32_16x16x32_bf16 v[52:55], a[152:155], v[36:39], v[52:55]
    v_mfma_f32_16x16x32_bf16 v[56:59], a[164:167], v[36:39], v[56:59]
    s_waitcnt vmcnt(39)
    v_mfma_f32_16x16x32_bf16 v[52:55], a[168:171], v[40:43], v[52:55]
    v_mfma_f32_16x16x32_bf16 v[56:59], a[180:183], v[40:43], v[56:59]
    v_mfma_f32_16x16x32_bf16 v[52:55], a[172:175], v[44:47], v[52:55]
    v_mfma_f32_16x16x32_bf16 v[56:59], a[184:187], v[44:47], v[56:59]
    v_mfma_f32_16x16x32_bf16 v[52:55], a[176:179], v[48:51], v[52:55]
    v_mfma_f32_16x16x32_bf16 v[56:59], a[188:191], v[48:51], v[56:59]
    s_add_u32 s50, s49, 1120
    s_mul_i32 s50, s50, 49152
    s_waitcnt vmcnt(6)
    buffer_load_dwordx4 a[144:147], v2, s[4:7], s50 offen offset:0 nt
    s_waitcnt vmcnt(6)
    buffer_load_dwordx4 a[148:151], v2, s[4:7], s50 offen offset:128 nt
    s_waitcnt vmcnt(6)
    buffer_load_dwordx4 a[152:155], v2, s[4:7], s50 offen offset:256 nt
    s_waitcnt vmcnt(6)
    buffer_load_dwordx4 a[156:159], v2, s[4:7], s50 offen offset:384 nt
    s_waitcnt vmcnt(6)
    buffer_load_dwordx4 a[160:163], v2, s[4:7], s50 offen offset:512 nt
    s_waitcnt vmcnt(6)
    buffer_load_dwordx4 a[164:167], v2, s[4:7], s50 offen offset:640 nt
    s_waitcnt vmcnt(5)
    buffer_load_dwordx4 a[168:171], v2, s[4:7], s50 offen offset:768 nt
    s_waitcnt vmcnt(5)
    buffer_load_dwordx4 a[172:175], v2, s[4:7], s50 offen offset:896 nt
    s_waitcnt vmcnt(5)
    buffer_load_dwordx4 a[176:179], v2, s[4:7], s50 offen offset:1024 nt
    buffer_load_dwordx4 a[180:183], v2, s[4:7], s50 offen offset:1152 nt
    buffer_load_dwordx4 a[184:187], v2, s[4:7], s50 offen offset:1280 nt
    buffer_load_dwordx4 a[188:191], v2, s[4:7], s50 offen offset:1408 nt
    s_add_u32 s50, s49, 2048
    s_mul_i32 s50, s50, 49152
    buffer_load_dword v25, v16, s[4:7], s50 offen nt
    v_add_f32_dpp v68, v53, v52 quad_perm:[1,1,1,1] row_mask:0xf bank_mask:0xf
    v_add_f32_dpp v69, v55, v54 quad_perm:[3,3,3,3] row_mask:0xf bank_mask:0xf
    v_add_f32_dpp v70, v56, v57 quad_perm:[0,0,0,0] row_mask:0xf bank_mask:0xf
    v_add_f32_dpp v71, v58, v59 quad_perm:[2,2,2,2] row_mask:0xf bank_mask:0xf
    v_cndmask_b32 v68, v68, v70, s[64:65]
    v_cndmask_b32 v69, v69, v71, s[64:65]
    s_nop 1
    v_add_f32_dpp v68, v69, v68 quad_perm:[2,3,2,3] row_mask:0xf bank_mask:0xf
    s_nop 1
    v_mov_b32_dpp v69, v68 quad_perm:[0,1,0,1] row_mask:0xf bank_mask:0xf
    v_cvt_pk_bf16_f32 v69, v69, v69
    v_and_b32 v69, 0xffff0000, v69
    v_mul_f32 v69, 0x3d93cd3a, v69
    v_cvt_pk_bf16_f32 v79, v69, v69
    v_and_b32 v79, 0xffff0000, v79
    ds_write_b16_d16_hi v13, v79 offset:768
    v_max3_f32 v70, v76, v77, v78
    v_max_f32 v70, v70, v79
    s_nop 1
    v_max_f32_dpp v70, v70, v70 quad_perm:[1,0,3,2] row_mask:0xf bank_mask:0xf
    s_nop 1
    v_max_f32_dpp v70, v70, v70 row_half_mirror row_mask:0xf bank_mask:0xf
    s_nop 1
    v_max_f32_dpp v70, v70, v70 row_mirror row_mask:0xf bank_mask:0xf
    s_nop 1
    v_max_f32_dpp v70, v70, v70 row_bcast:15 row_mask:0xa bank_mask:0xf
    s_nop 1
    v_max_f32_dpp v70, v70, v70 row_bcast:31 row_mask:0xc bank_mask:0xf
    s_nop 0
    v_readlane_b32 s54, v70, 63
    s_nop 1
    v_subrev_f32 v76, s54, v76
    v_subrev_f32 v77, s54, v77
    v_subrev_f32 v78, s54, v78
    v_subrev_f32 v79, s54, v79
    v_mul_f32 v76, 0x3fb8aa3b, v76
    v_mul_f32 v77, 0x3fb8aa3b, v77
    v_mul_f32 v78, 0x3fb8aa3b, v78
    v_mul_f32 v79, 0x3fb8aa3b, v79
    v_exp_f32 v76, v76
    v_exp_f32 v77, v77
    v_exp_f32 v78, v78
    v_exp_f32 v79, v79
    v_add_f32 v76, v76, v77
    v_add_f32 v78, v78, v79
    v_add_f32 v71, v76, v78
    s_nop 1
    v_add_f32_dpp v71, v71, v71 quad_perm:[1,0,3,2] row_mask:0xf bank_mask:0xf
    s_nop 1
    v_add_f32_dpp v71, v71, v71 row_half_mirror row_mask:0xf bank_mask:0xf
    s_nop 1
    v_add_f32_dpp v71, v71, v71 row_mirror row_mask:0xf bank_mask:0xf
    s_nop 1
    v_add_f32_dpp v71, v71, v71 row_bcast:15 row_mask:0xa bank_mask:0xf
    s_nop 1
    v_add_f32_dpp v71, v71, v71 row_bcast:31 row_mask:0xc bank_mask:0xf
    s_mov_b64 exec, s[68:69]
    ds_write_b64 v15, v[70:71] offset:33280
    s_mov_b64 exec, -1
    v_add_u32 v13, 1024, v13
    v_add_u32 v15, 32, v15
    s_add_u32 s49, s49, 1024
    s_add_u32 s3, s3, 1
    s_cmp_lt_u32 s3, 7
    s_cbranch_scc1 L_kloop_15
    s_branch L_kend_13
.p2align 6
L_kloop_16:
    s_lshr_b32 s50, 0x14, s3
    s_and_b32 s50, s50, 1
    s_cbranch_scc1 L_hook_19
L_back_23:
    s_lshr_b32 s62, s49, 7
    s_mul_i32 s62, s62, 384
    v_mad_u32_u24 v68, v5, s62, v6
    v_mad_u32_u24 v69, v7, s62, v8
    ds_read_b128 v[28:31], v68 offset:0
    ds_read_b128 v[32:35], v68 offset:128
    ds_read_b128 v[36:39], v68 offset:256
    ds_read_b128 v[40:43], v69 offset:0
    ds_read_b128 v[44:47], v69 offset:128
    ds_read_b128 v[48:51], v69 offset:256
    s_waitcnt vmcnt(46) lgkmcnt(0)
    v_mfma_f32_16x16x32_bf16 v[52:55], a[0:3], v[28:31], 0
    v_mfma_f32_16x16x32_bf16 v[56:59], a[12:15], v[28:31], 0
    v_mfma_f32_16x16x32_bf16 v[52:55], a[4:7], v[32:35], v[52:55]
    v_mfma_f32_16x16x32_bf16 v[56:59], a[16:19], v[32:35], v[56:59]
    v_mfma_f32_16x16x32_bf16 v[52:55], a[8:11], v[36:39], v[52:55]
    v_mfma_f32_16x16x32_bf16 v[56:59], a[20:23], v[36:39], v[56:59]
    s_waitcnt vmcnt(40)
    v_mfma_f32_16x16x32_bf16 v[52:55], a[24:27], v[40:43], v[52:55]
    v_mfma_f32_16x16x32_bf16 v[56:59], a[36:39], v[40:43], v[56:59]
    v_mfma_f32_16x16x32_bf16 v[52:55], a[28:31], v[44:47], v[52:55]
    v_mfma_f32_16x16x32_bf16 v[56:59], a[40:43], v[44:47], v[56:59]
    v_mfma_f32_16x16x32_bf16 v[52:55], a[32:35], v[48:51], v[52:55]
    v_mfma_f32_16x16x32_bf16 v[56:59], a[44:47], v[48:51], v[56:59]
    s_add_u32 s50, s49, 1024
    s_mul_i32 s50, s50, 49152
    s_waitcnt vmcnt(6)
    buffer_load_dwordx4 a[0:3], v2, s[4:7], s50 offen offset:0 nt
    s_waitcnt vmcnt(6)
    buffer_load_dwordx4 a[4:7], v2, s[4:7], s50 offen offset:128 nt
    s_waitcnt vmcnt(6)
    buffer_load_dwordx4 a[8:11], v2, s[4:7], s50 offen offset:256 nt
    s_waitcnt vmcnt(6)
    buffer_load_dwordx4 a[12:15], v2, s[4:7], s50 offen offset:384 nt
    s_waitcnt vmcnt(6)
    buffer_load_dwordx4 a[16:19], v2, s[4:7], s50 offen offset:512 nt
    s_waitcnt vmcnt(6)
    buffer_load_dwordx4 a[20:23], v2, s[4:7], s50 offen offset:640 nt
    s_waitcnt vmcnt(6)
    buffer_load_dwordx4 a[24:27], v2, s[4:7], s50 offen offset:768 nt
    s_waitcnt vmcnt(6)
    buffer_load_dwordx4 a[28:31], v2, s[4:7], s50 offen offset:896 nt
    s_waitcnt vmcnt(6)
    buffer_load_dwordx4 a[32:35], v2, s[4:7], s50 offen offset:1024 nt
    s_waitcnt vmcnt(6)
    buffer_load_dwordx4 a[36:39], v2, s[4:7], s50 offen offset:1152 nt
    buffer_load_dwordx4 a[40:43], v2, s[4:7], s50 offen offset:1280 nt
    buffer_load_dwordx4 a[44:47], v2, s[4:7], s50 offen offset:1408 nt
    s_add_u32 s50, s49, 1056
    s_mul_i32 s50, s50, 49152
    buffer_load_dword v25, v16, s[4:7], s50 offen nt
    v_add_f32_dpp v68, v53, v52 quad_perm:[1,1,1,1] row_mask:0xf bank_mask:0xf
    v_add_f32_dpp v69, v55, v54 quad_perm:[3,3,3,3] row_mask:0xf bank_mask:0xf
    v_add_f32_dpp v70, v56, v57 quad_perm:[0,0,0,0] row_mask:0xf bank_mask:0xf
    v_add_f32_dpp v71, v58, v59 quad_perm:[2,2,2,2] row_mask:0xf bank_mask:0xf
    v_cndmask_b32 v68, v68, v70, s[64:65]
    v_cndmask_b32 v69, v69, v71, s[64:65]
    s_nop 1
    v_add_f32_dpp v68, v69, v68 quad_perm:[2,3,2,3] row_mask:0xf bank_mask:0xf
    s_nop 1
    v_mov_b32_dpp v69, v68 quad_perm:[0,1,0,1] row_mask:0xf bank_mask:0xf
    v_cvt_pk_bf16_f32 v69, v69, v69
    v_and_b32 v69, 0xffff0000, v69
    v_mul_f32 v69, 0x3d93cd3a, v69
    v_cvt_pk_bf16_f32 v76, v69, v69
    v_and_b32 v76, 0xffff0000, v76
    ds_write_b16_d16_hi v13, v76 offset:0
    s_waitcnt vmcnt(46)
    v_mfma_f32_16x16x32_bf16 v[52:55], a[48:51], v[28:31], 0
    v_mfma_f32_16x16x32_bf16 v[56:59], a[60:63], v[28:31], 0
    v_mfma_f32_16x16x32_bf16 v[52:55], a[52:55], v[32:35], v[52:55]
    v_mfma_f32_16x16x32_bf16 v[56:59], a[64:67], v[32:35], v[56:59]
    v_mfma_f32_16x16x32_bf16 v[52:55], a[56:59], v[36:39], v[52:55]
    v_mfma_f32_16x16x32_bf16 v[56:59], a[68:71], v[36:39], v[56:59]
    s_waitcnt vmcnt(40)
    v_mfma_f32_16x16x32_bf16 v[52:55], a[72:75], v[40:43], v[52:55]
    v_mfma_f32_16x16x32_bf16 v[56:59], a[84:87], v[40:43], v[56:59]
    v_mfma_f32_16x16x32_bf16 v[52:55], a[76:79], v[44:47], v[52:55]
    v_mfma_f32_16x16x32_bf16 v[56:59], a[88:91], v[44:47], v[56:59]
    v_mfma_f32_16x16x32_bf16 v[52:55], a[80:83], v[48:51], v[52:55]
    v_mfma_f32_16x16x32_bf16 v[56:59], a[92:95], v[48:51], v[56:59]
    s_add_u32 s50, s49, 1056
    s_mul_i32 s50, s50, 49152
    s_waitcnt vmcnt(7)
    buffer_load_dwordx4 a[48:51], v2, s[4:7], s50 offen offset:0 nt
    s_waitcnt vmcnt(7)
    buffer_load_dwordx4 a[52:55], v2, s[4:7], s50 offen offset:128 nt
    s_waitcnt vmcnt(7)
    buffer_load_dwordx4 a[56:59], v2, s[4:7], s50 offen offset:256 nt
    s_waitcnt vmcnt(7)
    buffer_load_dwordx4 a[60:63], v2, s[4:7], s50 offen offset:384 nt
    s_waitcnt vmcnt(7)
    buffer_load_dwordx4 a[64:67], v2, s[4:7], s50 offen offset:512 nt
    s_waitcnt vmcnt(7)
    buffer_load_dwordx4 a[68:71], v2, s[4:7], s50 offen offset:640 nt
    s_waitcnt vmcnt(7)
    buffer_load_dwordx4 a[72:75], v2, s[4:7], s50 offen offset:768 nt
    s_waitcnt vmcnt(6)
    buffer_load_dwordx4 a[76:79], v2, s[4:7], s50 offen offset:896 nt
    s_waitcnt vmcnt(6)
    buffer_load_dwordx4 a[80:83], v2, s[4:7], s50 offen offset:1024 nt
    s_waitcnt vmcnt(6)
    buffer_load_dwordx4 a[84:87], v2, s[4:7], s50 offen offset:1152 nt
    buffer_load_dwordx4 a[88:91], v2, s[4:7], s50 offen offset:1280 nt
    buffer_load_dwordx4 a[92:95], v2, s[4:7], s50 offen offset:1408 nt
    s_add_u32 s50, s49, 1088
    s_mul_i32 s50, s50, 49152
    buffer_load_dword v25, v16, s[4:7], s50 offen nt
    v_add_f32_dpp v68, v53, v52 quad_perm:[1,1,1,1] row_mask:0xf bank_mask:0xf
    v_add_f32_dpp v69, v55, v54 quad_perm:[3,3,3,3] row_mask:0xf bank_mask:0xf
    v_add_f32_dpp v70, v56, v57 quad_perm:[0,0,0,0] row_mask:0xf bank_mask:0xf
    v_add_f32_dpp v71, v58, v59 quad_perm:[2,2,2,2] row_mask:0xf bank_mask:0xf
    v_cndmask_b32 v68, v68, v70, s[64:65]
    v_cndmask_b32 v69, v69, v71, s[64:65]
    s_nop 1
    v_add_f32_dpp v68, v69, v68 quad_perm:[2,3,2,3] row_mask:0xf bank_mask:0xf
    s_nop 1
    v_mov_b32_dpp v69, v68 quad_perm:[0,1,0,1] row_mask:0xf bank_mask:0xf
    v_cvt_pk_bf16_f32 v69, v69, v69
    v_and_b32 v69, 0xffff0000, v69
    v_mul_f32 v69, 0x3d93cd3a, v69
    v_cvt_pk_bf16_f32 v77, v69, v69
    v_and_b32 v77, 0xffff0000, v77
    ds_write_b16_d16_hi v13, v77 offset:256
    s_waitcnt vmcnt(44)
    v_mfma_f32_16x16x32_bf16 v[52:55], a[96:99], v[28:31], 0
    v_mfma_f32_16x16x32_bf16 v[56:59], a[108:111], v[28:31], 0
    v_mfma_f32_16x16x32_bf16 v[52:55], a[100:103], v[32:35], v[52:55]
    v_mfma_f32_16x16x32_bf16 v[56:59], a[112:115], v[32:35], v[56:59]
    v_mfma_f32_16x16x32_bf16 v[52:55], a[104:107], v[36:39], v[52:55]
    v_mfma_f32_16x16x32_bf16 v[56:59], a[116:119], v[36:39], v[56:59]
    s_waitcnt vmcnt(38)
    v_mfma_f32_16x16x32_bf16 v[52:55], a[120:123], v[40:43], v[52:55]
    v_mfma_f32_16x16x32_bf16 v[56:59], a[132:135], v[40:43], v[56:59]
    v_mfma_f32_16x16x32_bf16 v[52:55], a[124:127], v[44:47], v[52:55]
    v_mfma_f32_16x16x32_bf16 v[56:59], a[136:139], v[44:47], v[56:59]
    v_mfma_f32_16x16x32_bf16 v[52:55], a[128:131], v[48:51], v[52:55]
    v_mfma_f32_16x16x32_bf16 v[56:59], a[140:143], v[48:51], v[56:59]
    s_add_u32 s50, s49, 1088
    s_mul_i32 s50, s50, 49152
    s_waitcnt vmcnt(7)
    buffer_load_dwordx4 a[96:99], v2, s[4:7], s50 offen offset:0 nt
    s_waitcnt vmcnt(7)
    buffer_load_dwordx4 a[100:103], v2, s[4:7], s50 offen offset:128 nt
    s_waitcnt vmcnt(7)
    buffer_load_dwordx4 a[104:107], v2, s[4:7], s50 offen offset:256 nt
    s_waitcnt vmcnt(7)
    buffer_load_dwordx4 a[108:111], v2, s[4:7], s50 offen offset:384 nt
    s_waitcnt vmcnt(7)
    buffer_load_dwordx4 a[112:115], v2, s[4:7], s50 offen offset:512 nt
    s_waitcnt vmcnt(7)
    buffer_load_dwordx4 a[116:119], v2, s[4:7], s50 offen offset:640 nt
    s_waitcnt vmcnt(7)
    buffer_load_dwordx4 a[120:123], v2, s[4:7], s50 offen offset:768 nt
    s_waitcnt vmcnt(6)
    buffer_load_dwordx4 a[124:127], v2, s[4:7], s50 offen offset:896 nt
    s_waitcnt vmcnt(6)
    buffer_load_dwordx4 a[128:131], v2, s[4:7], s50 offen offset:1024 nt
    s_waitcnt vmcnt(6)
    buffer_load_dwordx4 a[132:135], v2, s[4:7], s50 offen offset:1152 nt
    buffer_load_dwordx4 a[136:139], v2, s[4:7], s50 offen offset:1280 nt
    buffer_load_dwordx4 a[140:143], v2, s[4:7], s50 offen offset:1408 nt
    s_add_u32 s50, s49, 1120
    s_mul_i32 s50, s50, 49152
    buffer_load_dword v25, v16, s[4:7], s50 offen nt
    v_add_f32_dpp v68, v53, v52 quad_perm:[1,1,1,1] row_mask:0xf bank_mask:0xf
    v_add_f32_dpp v69, v55, v54 quad_perm:[3,3,3,3] row_mask:0xf bank_mask:0xf
    v_add_f32_dpp v70, v56, v57 quad_perm:[0,0,0,0] row_mask:0xf bank_mask:0xf
    v_add_f32_dpp v71, v58, v59 quad_perm:[2,2,2,2] row_mask:0xf bank_mask:0xf
    v_cndmask_b32 v68, v68, v70, s[64:65]
    v_cndmask_b32 v69, v69, v71, s[64:65]
    s_nop 1
    v_add_f32_dpp v68, v69, v68 quad_perm:[2,3,2,3] row_mask:0xf bank_mask:0xf
    s_nop 1
    v_mov_b32_dpp v69, v68 quad_perm:[0,1,0,1] row_mask:0xf bank_mask:0xf
    v_cvt_pk_bf16_f32 v69, v69, v69
    v_and_b32 v69, 0xffff0000, v69
    v_mul_f32 v69, 0x3d93cd3a, v69
    v_cvt_pk_bf16_f32 v78, v69, v69
    v_and_b32 v78, 0xffff0000, v78
    ds_write_b16_d16_hi v13, v78 offset:512
    s_waitcnt vmcnt(45)
    v_mfma_f32_16x16x32_bf16 v[52:55], a[144:147], v[28:31], 0
    v_mfma_f32_16x16x32_bf16 v[56:59], a[156:159], v[28:31], 0
    v_mfma_f32_16x16x32_bf16 v[52:55], a[148:151], v[32:35], v[52:55]
    v_mfma_f32_16x16x32_bf16 v[56:59], a[160:163], v[32:35], v[56:59]
    v_mfma_f32_16x16x32_bf16 v[52:55], a[152:155], v[36:39], v[52:55]
    v_mfma_f32_16x16x32_bf16 v[56:59], a[164:167], v[36:39], v[56:59]
    s_waitcnt vmcnt(39)
    v_mfma_f32_16x16x32_bf16 v[52:55], a[168:171], v[40:43], v[52:55]
    v_mfma_f32_16x16x32_bf16 v[56:59], a[180:183], v[40:43], v[56:59]
    v_mfma_f32_16x16x32_bf16 v[52:55], a[172:175], v[44:47], v[52:55]
    v_mfma_f32_16x16x32_bf16 v[56:59], a[184:187], v[44:47], v[56:59]
    v_mfma_f32_16x16x32_bf16 v[52:55], a[176:179], v[48:51], v[52:55]
    v_mfma_f32_16x16x32_bf16 v[56:59], a[188:191], v[48:51], v[56:59]
    s_add_u32 s50, s49, 1120
    s_mul_i32 s50, s50, 49152
    s_waitcnt vmcnt(7)
    buffer_load_dwordx4 a[144:147], v2, s[4:7], s50 offen offset:0 nt
    s_waitcnt vmcnt(7)
    buffer_load_dwordx4 a[148:151], v2, s[4:7], s50 offen offset:128 nt
    s_waitcnt vmcnt(7)
    buffer_load_dwordx4 a[152:155], v2, s[4:7], s50 offen offset:256 nt
    s_waitcnt vmcnt(7)
    buffer_load_dwordx4 a[156:159], v2, s[4:7], s50 offen offset:384 nt
    s_waitcnt vmcnt(7)
    buffer_load_dwordx4 a[160:163], v2, s[4:7], s50 offen offset:512 nt
    s_waitcnt vmcnt(7)
    buffer_load_dwordx4 a[164:167], v2, s[4:7], s50 offen offset:640 nt
    s_waitcnt vmcnt(7)
    buffer_load_dwordx4 a[168:171], v2, s[4:7], s50 offen offset:768 nt
    s_waitcnt vmcnt(6)
    buffer_load_dwordx4 a[172:175], v2, s[4:7], s50 offen offset:896 nt
    s_waitcnt vmcnt(6)
    buffer_load_dwordx4 a[176:179], v2, s[4:7], s50 offen offset:1024 nt
    buffer_load_dwordx4 a[180:183], v2, s[4:7], s50 offen offset:1152 nt
    buffer_load_dwordx4 a[184:187], v2, s[4:7], s50 offen offset:1280 nt
    buffer_load_dwordx4 a[188:191], v2, s[4:7], s50 offen offset:1408 nt
    s_add_u32 s50, s49, 2048
    s_mul_i32 s50, s50, 49152
    buffer_load_dword v25, v16, s[4:7], s50 offen nt
    v_add_f32_dpp v68, v53, v52 quad_perm:[1,1,1,1] row_mask:0xf bank_mask:0xf
    v_add_f32_dpp v69, v55, v54 quad_perm:[3,3,3,3] row_mask:0xf bank_mask:0xf
    v_add_f32_dpp v70, v56, v57 quad_perm:[0,0,0,0] row_mask:0xf bank_mask:0xf
    v_add_f32_dpp v71, v58, v59 quad_perm:[2,2,2,2] row_mask:0xf bank_mask:0xf
    v_cndmask_b32 v68, v68, v70, s[64:65]
    v_cndmask_b32 v69, v69, v71, s[64:65]
    s_nop 1
    v_add_f32_dpp v68, v69, v68 quad_perm:[2,3,2,3] row_mask:0xf bank_mask:0xf
    s_nop 1
    v_mov_b32_dpp v69, v68 quad_perm:[0,1,0,1] row_mask:0xf bank_mask:0xf
    v_cvt_pk_bf16_f32 v69, v69, v69
    v_and_b32 v69, 0xffff0000, v69
    v_mul_f32 v69, 0x3d93cd3a, v69
    v_cvt_pk_bf16_f32 v79, v69, v69
    v_and_b32 v79, 0xffff0000, v79
    ds_write_b16_d16_hi v13, v79 offset:768
    v_max3_f32 v70, v76, v77, v78
    v_max_f32 v70, v70, v79
    s_nop 1
    v_max_f32_dpp v70, v70, v70 quad_perm:[1,0,3,2] row_mask:0xf bank_mask:0xf
    s_nop 1
    v_max_f32_dpp v70, v70, v70 row_half_mirror row_mask:0xf bank_mask:0xf
    s_nop 1
    v_max_f32_dpp v70, v70, v70 row_mirror row_mask:0xf bank_mask:0xf
    s_nop 1
    v_max_f32_dpp v70, v70, v70 row_bcast:15 row_mask:0xa bank_mask:0xf
    s_nop 1
    v_max_f32_dpp v70, v70, v70 row_bcast:31 row_mask:0xc bank_mask:0xf
    s_nop 0
    v_readlane_b32 s54, v70, 63
    s_nop 1
    v_subrev_f32 v76, s54, v76
    v_subrev_f32 v77, s54, v77
    v_subrev_f32 v78, s54, v78
    v_subrev_f32 v79, s54, v79
    v_mul_f32 v76, 0x3fb8aa3b, v76
    v_mul_f32 v77, 0x3fb8aa3b, v77
    v_mul_f32 v78, 0x3fb8aa3b, v78
    v_mul_f32 v79, 0x3fb8aa3b, v79
    v_exp_f32 v76, v76
    v_exp_f32 v77, v77
    v_exp_f32 v78, v78
    v_exp_f32 v79, v79
    v_add_f32 v76, v76, v77
    v_add_f32 v78, v78, v79
    v_add_f32 v71, v76, v78
    s_nop 1
    v_add_f32_dpp v71, v71, v71 quad_perm:[1,0,3,2] row_mask:0xf bank_mask:0xf
    s_nop 1
    v_add_f32_dpp v71, v71, v71 row_half_mirror row_mask:0xf bank_mask:0xf
    s_nop 1
    v_add_f32_dpp v71, v71, v71 row_mirror row_mask:0xf bank_mask:0xf
    s_nop 1
    v_add_f32_dpp v71, v71, v71 row_bcast:15 row_mask:0xa bank_mask:0xf
    s_nop 1
    v_add_f32_dpp v71, v71, v71 row_bcast:31 row_mask:0xc bank_mask:0xf
    s_mov_b64 exec, s[68:69]
    ds_write_b64 v15, v[70:71] offset:33280
    s_mov_b64 exec, -1
    v_add_u32 v13, 1024, v13
    v_add_u32 v15, 32, v15
    s_add_u32 s49, s49, 1024
    s_add_u32 s3, s3, 1
    s_cmp_lt_u32 s3, 7
    s_cbranch_scc1 L_kloop_16
L_kend_13:
    s_lshr_b32 s62, s49, 7
    s_mul_i32 s62, s62, 384
    v_mad_u32_u24 v68, v5, s62, v6
    v_mad_u32_u24 v69, v7, s62, v8
    ds_read_b128 v[28:31], v68 offset:0
    ds_read_b128 v[32:35], v68 offset:128
    ds_read_b128 v[36:39], v68 offset:256
    ds_read_b128 v[40:43], v69 offset:0
    ds_read_b128 v[44:47], v69 offset:128
    ds_read_b128 v[48:51], v69 offset:256
    s_waitcnt lgkmcnt(0)
    v_mfma_f32_16x16x32_bf16 v[52:55], a[0:3], v[28:31], 0
    v_mfma_f32_16x16x32_bf16 v[56:59], a[12:15], v[28:31], 0
    v_mfma_f32_16x16x32_bf16 v[52:55], a[4:7], v[32:35], v[52:55]
    v_mfma_f32_16x16x32_bf16 v[56:59], a[16:19], v[32:35], v[56:59]
    v_mfma_f32_16x16x32_bf16 v[52:55], a[8:11], v[36:39], v[52:55]
    v_mfma_f32_16x16x32_bf16 v[56:59], a[20:23], v[36:39], v[56:59]
    v_mfma_f32_16x16x32_bf16 v[52:55], a[24:27], v[40:43], v[52:55]
    v_mfma_f32_16x16x32_bf16 v[56:59], a[36:39], v[40:43], v[56:59]
    v_mfma_f32_16x16x32_bf16 v[52:55], a[28:31], v[44:47], v[52:55]
    v_mfma_f32_16x16x32_bf16 v[56:59], a[40:43], v[44:47], v[56:59]
    v_mfma_f32_16x16x32_bf16 v[52:55], a[32:35], v[48:51], v[52:55]
    v_mfma_f32_16x16x32_bf16 v[56:59], a[44:47], v[48:51], v[56:59]
    s_add_u32 s51, s49, -7168
    s_lshr_b32 s51, s51, 7
    s_lshl_b32 s51, s51, 9
    s_add_u32 s51, s51, 786432
    buffer_load_dwordx4 v[104:107], v24, s[12:15], s51 offen sc1
    s_sub_u32 s50, s49, 7168
    s_mul_i32 s50, s50, 49152
    s_waitcnt vmcnt(6)
    buffer_load_dwordx4 a[0:3], v3, s[8:11], s50 offen offset:0 nt
    s_waitcnt vmcnt(6)
    buffer_load_dwordx4 a[4:7], v3, s[8:11], s50 offen offset:128 nt
    s_waitcnt vmcnt(6)
    buffer_load_dwordx4 a[8:11], v3, s[8:11], s50 offen offset:256 nt
    s_waitcnt vmcnt(6)
    buffer_load_dwordx4 a[12:15], v3, s[8:11], s50 offen offset:384 nt
    s_waitcnt vmcnt(6)
    buffer_load_dwordx4 a[16:19], v3, s[8:11], s50 offen offset:512 nt
    s_waitcnt vmcnt(4)
    buffer_load_dwordx4 a[20:23], v3, s[8:11], s50 offen offset:640 nt
    s_waitcnt vmcnt(4)
    buffer_load_dwordx4 a[24:27], v3, s[8:11], s50 offen offset:768 nt
    s_waitcnt vmcnt(4)
    buffer_load_dwordx4 a[28:31], v3, s[8:11], s50 offen offset:896 nt
    s_waitcnt vmcnt(4)
    buffer_load_dwordx4 a[32:35], v3, s[8:11], s50 offen offset:1024 nt
    s_waitcnt vmcnt(4)
    buffer_load_dwordx4 a[36:39], v3, s[8:11], s50 offen offset:1152 nt
    buffer_load_dwordx4 a[40:43], v3, s[8:11], s50 offen offset:1280 nt
    buffer_load_dwordx4 a[44:47], v3, s[8:11], s50 offen offset:1408 nt
    v_add_f32_dpp v68, v53, v52 quad_perm:[1,1,1,1] row_mask:0xf bank_mask:0xf
    v_add_f32_dpp v69, v55, v54 quad_perm:[3,3,3,3] row_mask:0xf bank_mask:0xf
    v_add_f32_dpp v70, v56, v57 quad_perm:[0,0,0,0] row_mask:0xf bank_mask:0xf
    v_add_f32_dpp v71, v58, v59 quad_perm:[2,2,2,2] row_mask:0xf bank_mask:0xf
    v_cndmask_b32 v68, v68, v70, s[64:65]
    v_cndmask_b32 v69, v69, v71, s[64:65]
    s_nop 1
    v_add_f32_dpp v68, v69, v68 quad_perm:[2,3,2,3] row_mask:0xf bank_mask:0xf
    s_nop 1
    v_mov_b32_dpp v69, v68 quad_perm:[0,1,0,1] row_mask:0xf bank_mask:0xf
    v_cvt_pk_bf16_f32 v69, v69, v69
    v_and_b32 v69, 0xffff0000, v69
    v_mul_f32 v69, 0x3d93cd3a, v69
    v_cvt_pk_bf16_f32 v76, v69, v69
    v_and_b32 v76, 0xffff0000, v76
    ds_write_b16_d16_hi v13, v76 offset:0
    v_mfma_f32_16x16x32_bf16 v[52:55], a[48:51], v[28:31], 0
    v_mfma_f32_16x16x32_bf16 v[56:59], a[60:63], v[28:31], 0
    v_mfma_f32_16x16x32_bf16 v[52:55], a[52:55], v[32:35], v[52:55]
    v_mfma_f32_16x16x32_bf16 v[56:59], a[64:67], v[32:35], v[56:59]
    v_mfma_f32_16x16x32_bf16 v[52:55], a[56:59], v[36:39], v[52:55]
    v_mfma_f32_16x16x32_bf16 v[56:59], a[68:71], v[36:39], v[56:59]
    v_mfma_f32_16x16x32_bf16 v[52:55], a[72:75], v[40:43], v[52:55]
    v_mfma_f32_16x16x32_bf16 v[56:59], a[84:87], v[40:43], v[56:59]
    v_mfma_f32_16x16x32_bf16 v[52:55], a[76:79], v[44:47], v[52:55]
    v_mfma_f32_16x16x32_bf16 v[56:59], a[88:91], v[44:47], v[56:59]
    v_mfma_f32_16x16x32_bf16 v[52:55], a[80:83], v[48:51], v[52:55]
    v_mfma_f32_16x16x32_bf16 v[56:59], a[92:95], v[48:51], v[56:59]
    s_nop 6
    v_add_f32_dpp v68, v53, v52 quad_perm:[1,1,1,1] row_mask:0xf bank_mask:0xf
    v_add_f32_dpp v69, v55, v54 quad_perm:[3,3,3,3] row_mask:0xf bank_mask:0xf
    v_add_f32_dpp v70, v56, v57 quad_perm:[0,0,0,0] row_mask:0xf bank_mask:0xf
    v_add_f32_dpp v71, v58, v59 quad_perm:[2,2,2,2] row_mask:0xf bank_mask:0xf
    v_cndmask_b32 v68, v68, v70, s[64:65]
    v_cndmask_b32 v69, v69, v71, s[64:65]
    s_nop 1
    v_add_f32_dpp v68, v69, v68 quad_perm:[2,3,2,3] row_mask:0xf bank_mask:0xf
    s_nop 1
    v_mov_b32_dpp v69, v68 quad_perm:[0,1,0,1] row_mask:0xf bank_mask:0xf
    v_cvt_pk_bf16_f32 v69, v69, v69
    v_and_b32 v69, 0xffff0000, v69
    v_mul_f32 v69, 0x3d93cd3a, v69
    v_cvt_pk_bf16_f32 v77, v69, v69
    v_and_b32 v77, 0xffff0000, v77
    ds_write_b16_d16_hi v13, v77 offset:256
    v_mfma_f32_16x16x32_bf16 v[52:55], a[96:99], v[28:31], 0
    v_mfma_f32_16x16x32_bf16 v[56:59], a[108:111], v[28:31], 0
    v_mfma_f32_16x16x32_bf16 v[52:55], a[100:103], v[32:35], v[52:55]
    v_mfma_f32_16x16x32_bf16 v[56:59], a[112:115], v[32:35], v[56:59]
    v_mfma_f32_16x16x32_bf16 v[52:55], a[104:107], v[36:39], v[52:55]
    v_mfma_f32_16x16x32_bf16 v[56:59], a[116:119], v[36:39], v[56:59]
    v_mfma_f32_16x16x32_bf16 v[52:55], a[120:123], v[40:43], v[52:55]
    v_mfma_f32_16x16x32_bf16 v[56:59], a[132:135], v[40:43], v[56:59]
    v_mfma_f32_16x16x32_bf16 v[52:55], a[124:127], v[44:47], v[52:55]
    v_mfma_f32_16x16x32_bf16 v[56:59], a[136:139], v[44:47], v[56:59]
    v_mfma_f32_16x16x32_bf16 v[52:55], a[128:131], v[48:51], v[52:55]
    v_mfma_f32_16x16x32_bf16 v[56:59], a[140:143], v[48:51], v[56:59]
    s_sub_u32 s50, s49, 7136
    s_mul_i32 s50, s50, 49152
    s_waitcnt vmcnt(4)
    buffer_load_dwordx4 a[48:51], v3, s[8:11], s50 offen offset:0 nt
    s_waitcnt vmcnt(4)
    buffer_load_dwordx4 a[52:55], v3, s[8:11], s50 offen offset:128 nt
    s_waitcnt vmcnt(4)
    buffer_load_dwordx4 a[56:59], v3, s[8:11], s50 offen offset:256 nt
    s_waitcnt vmcnt(4)
    buffer_load_dwordx4 a[60:63], v3, s[8:11], s50 offen offset:384 nt
    s_waitcnt vmcnt(4)
    buffer_load_dwordx4 a[64:67], v3, s[8:11], s50 offen offset:512 nt
    s_waitcnt vmcnt(4)
    buffer_load_dwordx4 a[68:71], v3, s[8:11], s50 offen offset:640 nt
    s_waitcnt vmcnt(4)
    buffer_load_dwordx4 a[72:75], v3, s[8:11], s50 offen offset:768 nt
    s_waitcnt vmcnt(4)
    buffer_load_dwordx4 a[76:79], v3, s[8:11], s50 offen offset:896 nt
    s_waitcnt vmcnt(4)
    buffer_load_dwordx4 a[80:83], v3, s[8:11], s50 offen offset:1024 nt
    s_waitcnt vmcnt(4)
    buffer_load_dwordx4 a[84:87], v3, s[8:11], s50 offen offset:1152 nt
    buffer_load_dwordx4 a[88:91], v3, s[8:11], s50 offen offset:1280 nt
    buffer_load_dwordx4 a[92:95], v3, s[8:11], s50 offen offset:1408 nt
    v_add_f32_dpp v68, v53, v52 quad_perm:[1,1,1,1] row_mask:0xf bank_mask:0xf
    v_add_f32_dpp v69, v55, v54 quad_perm:[3,3,3,3] row_mask:0xf bank_mask:0xf
    v_add_f32_dpp v70, v56, v57 quad_perm:[0,0,0,0] row_mask:0xf bank_mask:0xf
    v_add_f32_dpp v71, v58, v59 quad_perm:[2,2,2,2] row_mask:0xf bank_mask:0xf
    v_cndmask_b32 v68, v68, v70, s[64:65]
    v_cndmask_b32 v69, v69, v71, s[64:65]
    s_nop 1
    v_add_f32_dpp v68, v69, v68 quad_perm:[2,3,2,3] row_mask:0xf bank_mask:0xf
    s_nop 1
    v_mov_b32_dpp v69, v68 quad_perm:[0,1,0,1] row_mask:0xf bank_mask:0xf
    v_cvt_pk_bf16_f32 v69, v69, v69
    v_and_b32 v69, 0xffff0000, v69
    v_mul_f32 v69, 0x3d93cd3a, v69
    v_cvt_pk_bf16_f32 v78, v69, v69
    v_and_b32 v78, 0xffff0000, v78
    ds_write_b16_d16_hi v13, v78 offset:512
    v_mfma_f32_16x16x32_bf16 v[52:55], a[144:147], v[28:31], 0
    v_mfma_f32_16x16x32_bf16 v[56:59], a[156:159], v[28:31], 0
    v_mfma_f32_16x16x32_bf16 v[52:55], a[148:151], v[32:35], v[52:55]
    v_mfma_f32_16x16x32_bf16 v[56:59], a[160:163], v[32:35], v[56:59]
    v_mfma_f32_16x16x32_bf16 v[52:55], a[152:155], v[36:39], v[52:55]
    v_mfma_f32_16x16x32_bf16 v[56:59], a[164:167], v[36:39], v[56:59]
    v_mfma_f32_16x16x32_bf16 v[52:55], a[168:171], v[40:43], v[52:55]
    v_mfma_f32_16x16x32_bf16 v[56:59], a[180:183], v[40:43], v[56:59]
    v_mfma_f32_16x16x32_bf16 v[52:55], a[172:175], v[44:47], v[52:55]
    v_mfma_f32_16x16x32_bf16 v[56:59], a[184:187], v[44:47], v[56:59]
    v_mfma_f32_16x16x32_bf16 v[52:55], a[176:179], v[48:51], v[52:55]
    v_mfma_f32_16x16x32_bf16 v[56:59], a[188:191], v[48:51], v[56:59]
    s_nop 6
    v_add_f32_dpp v68, v53, v52 quad_perm:[1,1,1,1] row_mask:0xf bank_mask:0xf
    v_add_f32_dpp v69, v55, v54 quad_perm:[3,3,3,3] row_mask:0xf bank_mask:0xf
    v_add_f32_dpp v70, v56, v57 quad_perm:[0,0,0,0] row_mask:0xf bank_mask:0xf
    v_add_f32_dpp v71, v58, v59 quad_perm:[2,2,2,2] row_mask:0xf bank_mask:0xf
    v_cndmask_b32 v68, v68, v70, s[64:65]
    v_cndmask_b32 v69, v69, v71, s[64:65]
    s_nop 1
    v_add_f32_dpp v68, v69, v68 quad_perm:[2,3,2,3] row_mask:0xf bank_mask:0xf
    s_nop 1
    v_mov_b32_dpp v69, v68 quad_perm:[0,1,0,1] row_mask:0xf bank_mask:0xf
    v_cvt_pk_bf16_f32 v69, v69, v69
    v_and_b32 v69, 0xffff0000, v69
    v_mul_f32 v69, 0x3d93cd3a, v69
    v_cvt_pk_bf16_f32 v79, v69, v69
    v_and_b32 v79, 0xffff0000, v79
    ds_write_b16_d16_hi v13, v79 offset:768
    v_max3_f32 v70, v76, v77, v78
    v_max_f32 v70, v70, v79
    s_nop 1
    v_max_f32_dpp v70, v70, v70 quad_perm:[1,0,3,2] row_mask:0xf bank_mask:0xf
    s_nop 1
    v_max_f32_dpp v70, v70, v70 row_half_mirror row_mask:0xf bank_mask:0xf
    s_nop 1
    v_max_f32_dpp v70, v70, v70 row_mirror row_mask:0xf bank_mask:0xf
    s_nop 1
    v_max_f32_dpp v70, v70, v70 row_bcast:15 row_mask:0xa bank_mask:0xf
    s_nop 1
    v_max_f32_dpp v70, v70, v70 row_bcast:31 row_mask:0xc bank_mask:0xf
    s_nop 0
    v_readlane_b32 s54, v70, 63
    s_nop 1
    v_subrev_f32 v76, s54, v76
    v_subrev_f32 v77, s54, v77
    v_subrev_f32 v78, s54, v78
    v_subrev_f32 v79, s54, v79
    v_mul_f32 v76, 0x3fb8aa3b, v76
    v_mul_f32 v77, 0x3fb8aa3b, v77
    v_mul_f32 v78, 0x3fb8aa3b, v78
    v_mul_f32 v79, 0x3fb8aa3b, v79
    v_exp_f32 v76, v76
    v_exp_f32 v77, v77
    v_exp_f32 v78, v78
    v_exp_f32 v79, v79
    v_add_f32 v76, v76, v77
    v_add_f32 v78, v78, v79
    v_add_f32 v71, v76, v78
    s_nop 1
    v_add_f32_dpp v71, v71, v71 quad_perm:[1,0,3,2] row_mask:0xf bank_mask:0xf
    s_nop 1
    v_add_f32_dpp v71, v71, v71 row_half_mirror row_mask:0xf bank_mask:0xf
    s_nop 1
    v_add_f32_dpp v71, v71, v71 row_mirror row_mask:0xf bank_mask:0xf
    s_nop 1
    v_add_f32_dpp v71, v71, v71 row_bcast:15 row_mask:0xa bank_mask:0xf
    s_nop 1
    v_add_f32_dpp v71, v71, v71 row_bcast:31 row_mask:0xc bank_mask:0xf
    s_mov_b64 exec, s[68:69]
    ds_write_b64 v15, v[70:71] offset:33280
    s_mov_b64 exec, -1
    v_add_u32 v13, 1024, v13
    v_add_u32 v15, 32, v15
    s_add_u32 s49, s49, 1024
    s_waitcnt lgkmcnt(0)
    s_barrier
    v_and_b32 v68, 3, v1
    v_lshlrev_b32 v69, 5, v68
    ds_read_b128 v[76:79], v69 offset:33408
    ds_read_b128 v[80:83], v69 offset:33424
    v_lshlrev_b32 v68, 12, v68
    v_mov_b32 v69, 2146435072
    v_cmp_gt_u32 vcc, 4, v0
    s_nop 1
    v_cndmask_b32 v68, v69, v68, vcc
    s_lshl_b32 s50, s2, 4
    s_add_u32 s50, s50, 802816
    v_mov_b32 v86, s57
    s_waitcnt lgkmcnt(0)
    v_max3_f32 v84, v76, v78, v80
    v_max_f32 v84, v84, v82
    v_sub_f32 v76, v76, v84
    v_sub_f32 v78, v78, v84
    v_sub_f32 v80, v80, v84
    v_sub_f32 v82, v82, v84
    v_mul_f32 v76, 0x3fb8aa3b, v76
    v_mul_f32 v78, 0x3fb8aa3b, v78
    v_mul_f32 v80, 0x3fb8aa3b, v80
    v_mul_f32 v82, 0x3fb8aa3b, v82
    v_exp_f32 v76, v76
    v_exp_f32 v78, v78
    v_exp_f32 v80, v80
    v_exp_f32 v82, v82
    v_mul_f32 v85, v76, v77
    v_fmac_f32 v85, v78, v79
    v_fmac_f32 v85, v80, v81
    v_fmac_f32 v85, v82, v83
    buffer_store_dwordx4 v[84:87], v68, s[12:15], s50 offen sc1
    v_lshrrev_b32 v68, 3, v1
    v_and_b32 v70, 7, v1
    s_lshl_b32 s50, s48, 6
    v_lshl_add_u32 v71, v70, 3, s50
    v_min_u32 v80, 7, v68
    v_lshl_add_u32 v71, v80, 8, v71
    ds_read_b64 v[72:73], v71 offset:31232
    v_lshrrev_b32 v71, 5, v1
    v_lshlrev_b32 v71, 19, v71
    v_and_b32 v80, 3, v68
    v_lshl_add_u32 v71, v80, 14, v71
    v_lshl_add_u32 v71, v70, 4, v71
    v_cmp_gt_u32 vcc, 8, v68
    s_nop 1
    v_cndmask_b32 v71, v69, v71, vcc
    s_and_b32 s50, s2, 0xe0
    s_mul_i32 s50, s50, 3
    s_add_u32 s50, s50, s2
    s_lshl_b32 s50, s50, 9
    s_lshl_b32 s51, s48, 7
    s_add_u32 s50, s50, s51
    s_add_u32 s50, s50, 4194304
    v_mov_b32 v74, s57
    s_waitcnt lgkmcnt(0)
    buffer_store_dwordx4 v[72:75], v71, s[12:15], s50 offen sc1
    s_and_b32 s49, s2, 0xe0
    s_mul_i32 s49, s49, 3
    s_add_u32 s49, s49, s2
    s_mov_b32 s3, 0
.p2align 6
L_sloop_24:
    ds_read_b64 v[78:79], v14 offset:0
    ds_read_b64 v[80:81], v14 offset:256
    ds_read_b64 v[82:83], v14 offset:512
    ds_read_b64 v[84:85], v14 offset:768
    s_waitcnt vmcnt(26)
L_schk_27:
    v_cmp_ne_u32 s[76:77], s57, v106
    s_nop 0
    s_cmp_lg_u64 s[76:77], 0
    s_nop 1
    s_cbranch_scc1 L_sslow_25
L_sback_26:
    v_mov_b32 v68, v104
    s_nop 1
    v_max_f32_dpp v68, v68, v68 quad_perm:[1,0,3,2] row_mask:0xf bank_mask:0xf
    s_nop 1
    v_max_f32_dpp v68, v68, v68 quad_perm:[2,3,0,1] row_mask:0xf bank_mask:0xf
    s_nop 1
    v_max_f32_dpp v68, v68, v68 row_half_mirror row_mask:0xf bank_mask:0xf
    s_nop 1
    v_max_f32_dpp v68, v68, v68 row_mirror row_mask:0xf bank_mask:0xf
    s_nop 1
    v_max_f32_dpp v68, v68, v68 row_bcast:15 row_mask:0xa bank_mask:0xf
    s_nop 0
    v_readlane_b32 s54, v68, 31
    s_nop 1
    v_subrev_f32 v69, s54, v104
    v_mul_f32 v69, 0x3fb8aa3b, v69
    v_exp_f32 v69, v69
    s_nop 0
    v_mul_f32 v69, v69, v105
    s_nop 1
    v_add_f32_dpp v69, v69, v69 quad_perm:[1,0,3,2] row_mask:0xf bank_mask:0xf
    s_nop 1
    v_add_f32_dpp v69, v69, v69 quad_perm:[2,3,0,1] row_mask:0xf bank_mask:0xf
    s_nop 1
    v_add_f32_dpp v69, v69, v69 row_half_mirror row_mask:0xf bank_mask:0xf
    s_nop 1
    v_add_f32_dpp v69, v69, v69 row_mirror row_mask:0xf bank_mask:0xf
    s_nop 1
    v_add_f32_dpp v69, v69, v69 row_bcast:15 row_mask:0xa bank_mask:0xf
    s_nop 0
    v_readlane_b32 s55, v69, 31
    s_nop 1
    v_rcp_f32 v70, s55
    s_add_u32 s51, s49, 1024
    s_lshr_b32 s51, s51, 7
    s_lshl_b32 s51, s51, 9
    s_add_u32 s51, s51, 786432
    buffer_load_dwordx4 v[104:107], v24, s[12:15], s51 offen sc1
    s_waitcnt lgkmcnt(0)
    v_lshlrev_b32 v72, 16, v78
    v_and_b32 v73, 0xffff0000, v78
    v_lshlrev_b32 v74, 16, v79
    v_and_b32 v75, 0xffff0000, v79
    v_subrev_f32 v72, s54, v72
    v_subrev_f32 v73, s54, v73
    v_subrev_f32 v74, s54, v74
    v_subrev_f32 v75, s54, v75
    v_mul_f32 v72, 0x3fb8aa3b, v72
    v_mul_f32 v73, 0x3fb8aa3b, v73
    v_mul_f32 v74, 0x3fb8aa3b, v74
    v_mul_f32 v75, 0x3fb8aa3b, v75
    v_exp_f32 v72, v72
    v_exp_f32 v73, v73
    v_exp_f32 v74, v74
    v_exp_f32 v75, v75
    v_mul_f32 v72, v72, v70
    v_mul_f32 v73, v73, v70
    v_mul_f32 v74, v74, v70
    v_mul_f32 v75, v75, v70
    v_cvt_pk_bf16_f32 v72, v72, v72
    v_cvt_pk_bf16_f32 v73, v73, v73
    v_cvt_pk_bf16_f32 v74, v74, v74
    v_cvt_pk_bf16_f32 v75, v75, v75
    v_and_b32 v28, v72, v9
    v_and_b32 v29, v72, v10
    v_and_b32 v30, v72, v11
    v_and_b32 v31, v72, v12
    v_and_b32 v32, v73, v9
    v_and_b32 v33, v73, v10
    v_and_b32 v34, v73, v11
    v_and_b32 v35, v73, v12
    v_and_b32 v36, v74, v9
    v_and_b32 v37, v74, v10
    v_and_b32 v38, v74, v11
    v_and_b32 v39, v74, v12
    v_and_b32 v40, v75, v9
    v_and_b32 v41, v75, v10
    v_and_b32 v42, v75, v11
    v_and_b32 v43, v75, v12
    s_waitcnt vmcnt(24)
    v_mfma_f32_16x16x32_bf16 v[52:55], a[0:3], v[28:31], 0
    v_mfma_f32_16x16x32_bf16 v[56:59], a[4:7], v[28:31], 0
    v_mfma_f32_16x16x32_bf16 v[60:63], a[8:11], v[28:31], 0
    s_waitcnt vmcnt(21)
    v_mfma_f32_16x16x32_bf16 v[52:55], a[12:15], v[32:35], v[52:55]
    v_mfma_f32_16x16x32_bf16 v[56:59], a[16:19], v[32:35], v[56:59]
    v_mfma_f32_16x16x32_bf16 v[60:63], a[20:23], v[32:35], v[60:63]
    s_waitcnt vmcnt(18)
    v_mfma_f32_16x16x32_bf16 v[52:55], a[24:27], v[36:39], v[52:55]
    v_mfma_f32_16x16x32_bf16 v[56:59], a[28:31], v[36:39], v[56:59]
    v_mfma_f32_16x16x32_bf16 v[60:63], a[32:35], v[36:39], v[60:63]
    s_waitcnt vmcnt(15)
    v_mfma_f32_16x16x32_bf16 v[52:55], a[36:39], v[40:43], v[52:55]
    v_mfma_f32_16x16x32_bf16 v[56:59], a[40:43], v[40:43], v[56:59]
    v_mfma_f32_16x16x32_bf16 v[60:63], a[44:47], v[40:43], v[60:63]
    s_add_u32 s50, s49, 64
    s_mul_i32 s50, s50, 49152
    s_waitcnt vmcnt(6)
    buffer_load_dwordx4 a[0:3], v3, s[8:11], s50 offen offset:0 nt
    s_waitcnt vmcnt(6)
    buffer_load_dwordx4 a[4:7], v3, s[8:11], s50 offen offset:128 nt
    s_waitcnt vmcnt(6)
    buffer_load_dwordx4 a[8:11], v3, s[8:11], s50 offen offset:256 nt
    s_waitcnt vmcnt(6)
    buffer_load_dwordx4 a[12:15], v3, s[8:11], s50 offen offset:384 nt
    s_waitcnt vmcnt(6)
    buffer_load_dwordx4 a[16:19], v3, s[8:11], s50 offen offset:512 nt
    s_waitcnt vmcnt(4)
    buffer_load_dwordx4 a[20:23], v3, s[8:11], s50 offen offset:640 nt
    s_waitcnt vmcnt(4)
    buffer_load_dwordx4 a[24:27], v3, s[8:11], s50 offen offset:768 nt
    s_waitcnt vmcnt(4)
    buffer_load_dwordx4 a[28:31], v3, s[8:11], s50 offen offset:896 nt
    s_waitcnt vmcnt(4)
    buffer_load_dwordx4 a[32:35], v3, s[8:11], s50 offen offset:1024 nt
    s_waitcnt vmcnt(4)
    buffer_load_dwordx4 a[36:39], v3, s[8:11], s50 offen offset:1152 nt
    buffer_load_dwordx4 a[40:43], v3, s[8:11], s50 offen offset:1280 nt
    buffer_load_dwordx4 a[44:47], v3, s[8:11], s50 offen offset:1408 nt
    s_add_u32 s50, s49, 96
    s_mul_i32 s50, s50, 49152
    buffer_load_dword v25, v16, s[8:11], s50 offen nt
    v_lshlrev_b32 v72, 16, v80
    v_and_b32 v73, 0xffff0000, v80
    v_lshlrev_b32 v74, 16, v81
    v_and_b32 v75, 0xffff0000, v81
    v_subrev_f32 v72, s54, v72
    v_subrev_f32 v73, s54, v73
    v_subrev_f32 v74, s54, v74
    v_subrev_f32 v75, s54, v75
    v_mul_f32 v72, 0x3fb8aa3b, v72
    v_mul_f32 v73, 0x3fb8aa3b, v73
    v_mul_f32 v74, 0x3fb8aa3b, v74
    v_mul_f32 v75, 0x3fb8aa3b, v75
    v_exp_f32 v72, v72
    v_exp_f32 v73, v73
    v_exp_f32 v74, v74
    v_exp_f32 v75, v75
    v_mul_f32 v72, v72, v70
    v_mul_f32 v73, v73, v70
    v_mul_f32 v74, v74, v70
    v_mul_f32 v75, v75, v70
    v_cvt_pk_bf16_f32 v72, v72, v72
    v_cvt_pk_bf16_f32 v73, v73, v73
    v_cvt_pk_bf16_f32 v74, v74, v74
    v_cvt_pk_bf16_f32 v75, v75, v75
    v_and_b32 v28, v72, v9
    v_and_b32 v29, v72, v10
    v_and_b32 v30, v72, v11
    v_and_b32 v31, v72, v12
    v_and_b32 v32, v73, v9
    v_and_b32 v33, v73, v10
    v_and_b32 v34, v73, v11
    v_and_b32 v35, v73, v12
    v_and_b32 v36, v74, v9
    v_and_b32 v37, v74, v10
    v_and_b32 v38, v74, v11
    v_and_b32 v39, v74, v12
    v_and_b32 v40, v75, v9
    v_and_b32 v41, v75, v10
    v_and_b32 v42, v75, v11
    v_and_b32 v43, v75, v12
    s_waitcnt vmcnt(24)
    v_mfma_f32_16x16x32_bf16 v[52:55], a[48:51], v[28:31], v[52:55]
    v_mfma_f32_16x16x32_bf16 v[56:59], a[52:55], v[28:31], v[56:59]
    v_mfma_f32_16x16x32_bf16 v[60:63], a[56:59], v[28:31], v[60:63]
    s_waitcnt vmcnt(21)
    v_mfma_f32_16x16x32_bf16 v[52:55], a[60:63], v[32:35], v[52:55]
    v_mfma_f32_16x16x32_bf16 v[56:59], a[64:67], v[32:35], v[56:59]
    v_mfma_f32_16x16x32_bf16 v[60:63], a[68:71], v[32:35], v[60:63]
    s_waitcnt vmcnt(18)
    v_mfma_f32_16x16x32_bf16 v[52:55], a[72:75], v[36:39], v[52:55]
    v_mfma_f32_16x16x32_bf16 v[56:59], a[76:79], v[36:39], v[56:59]
    v_mfma_f32_16x16x32_bf16 v[60:63], a[80:83], v[36:39], v[60:63]
    s_waitcnt vmcnt(15)
    v_mfma_f32_16x16x32_bf16 v[52:55], a[84:87], v[40:43], v[52:55]
    v_mfma_f32_16x16x32_bf16 v[56:59], a[88:91], v[40:43], v[56:59]
    v_mfma_f32_16x16x32_bf16 v[60:63], a[92:95], v[40:43], v[60:63]
    s_add_u32 s50, s49, 96
    s_mul_i32 s50, s50, 49152
    s_waitcnt vmcnt(5)
    buffer_load_dwordx4 a[48:51], v3, s[8:11], s50 offen offset:0 nt
    s_waitcnt vmcnt(5)
    buffer_load_dwordx4 a[52:55], v3, s[8:11], s50 offen offset:128 nt
    s_waitcnt vmcnt(5)
    buffer_load_dwordx4 a[56:59], v3, s[8:11], s50 offen offset:256 nt
    s_waitcnt vmcnt(5)
    buffer_load_dwordx4 a[60:63], v3, s[8:11], s50 offen offset:384 nt
    s_waitcnt vmcnt(5)
    buffer_load_dwordx4 a[64:67], v3, s[8:11], s50 offen offset:512 nt
    s_waitcnt vmcnt(4)
    buffer_load_dwordx4 a[68:71], v3, s[8:11], s50 offen offset:640 nt
    s_waitcnt vmcnt(4)
    buffer_load_dwordx4 a[72:75], v3, s[8:11], s50 offen offset:768 nt
    s_waitcnt vmcnt(4)
    buffer_load_dwordx4 a[76:79], v3, s[8:11], s50 offen offset:896 nt
    s_waitcnt vmcnt(4)
    buffer_load_dwordx4 a[80:83], v3, s[8:11], s50 offen offset:1024 nt
    s_waitcnt vmcnt(4)
    buffer_load_dwordx4 a[84:87], v3, s[8:11], s50 offen offset:1152 nt
    buffer_load_dwordx4 a[88:91], v3, s[8:11], s50 offen offset:1280 nt
    buffer_load_dwordx4 a[92:95], v3, s[8:11], s50 offen offset:1408 nt
    s_add_u32 s50, s49, 1024
    s_mul_i32 s50, s50, 49152
    buffer_load_dword v25, v16, s[8:11], s50 offen nt
    v_lshlrev_b32 v72, 16, v82
    v_and_b32 v73, 0xffff0000, v82
    v_lshlrev_b32 v74, 16, v83
    v_and_b32 v75, 0xffff0000, v83
    v_subrev_f32 v72, s54, v72
    v_subrev_f32 v73, s54, v73
    v_subrev_f32 v74, s54, v74
    v_subrev_f32 v75, s54, v75
    v_mul_f32 v72, 0x3fb8aa3b, v72
    v_mul_f32 v73, 0x3fb8aa3b, v73
    v_mul_f32 v74, 0x3fb8aa3b, v74
    v_mul_f32 v75, 0x3fb8aa3b, v75
    v_exp_f32 v72, v72
    v_exp_f32 v73, v73
    v_exp_f32 v74, v74
    v_exp_f32 v75, v75
    v_mul_f32 v72, v72, v70
    v_mul_f32 v73, v73, v70
    v_mul_f32 v74, v74, v70
    v_mul_f32 v75, v75, v70
    v_cvt_pk_bf16_f32 v72, v72, v72
    v_cvt_pk_bf16_f32 v73, v73, v73
    v_cvt_pk_bf16_f32 v74, v74, v74
    v_cvt_pk_bf16_f32 v75, v75, v75
    v_and_b32 v28, v72, v9
    v_and_b32 v29, v72, v10
    v_and_b32 v30, v72, v11
    v_and_b32 v31, v72, v12
    v_and_b32 v32, v73, v9
    v_and_b32 v33, v73, v10
    v_and_b32 v34, v73, v11
    v_and_b32 v35, v73, v12
    v_and_b32 v36, v74, v9
    v_and_b32 v37, v74, v10
    v_and_b32 v38, v74, v11
    v_and_b32 v39, v74, v12
    v_and_b32 v40, v75, v9
    v_and_b32 v41, v75, v10
    v_and_b32 v42, v75, v11
    v_and_b32 v43, v75, v12
    s_waitcnt vmcnt(23)
    v_mfma_f32_16x16x32_bf16 v[52:55], a[0:3], v[28:31], v[52:55]
    v_mfma_f32_16x16x32_bf16 v[56:59], a[4:7], v[28:31], v[56:59]
    v_mfma_f32_16x16x32_bf16 v[60:63], a[8:11], v[28:31], v[60:63]
    s_waitcnt vmcnt(20)
    v_mfma_f32_16x16x32_bf16 v[52:55], a[12:15], v[32:35], v[52:55]
    v_mfma_f32_16x16x32_bf16 v[56:59], a[16:19], v[32:35], v[56:59]
    v_mfma_f32_16x16x32_bf16 v[60:63], a[20:23], v[32:35], v[60:63]
    s_waitcnt vmcnt(17)
    v_mfma_f32_16x16x32_bf16 v[52:55], a[24:27], v[36:39], v[52:55]
    v_mfma_f32_16x16x32_bf16 v[56:59], a[28:31], v[36:39], v[56:59]
    v_mfma_f32_16x16x32_bf16 v[60:63], a[32:35], v[36:39], v[60:63]
    s_waitcnt vmcnt(14)
    v_mfma_f32_16x16x32_bf16 v[52:55], a[36:39], v[40:43], v[52:55]
    v_mfma_f32_16x16x32_bf16 v[56:59], a[40:43], v[40:43], v[56:59]
    v_mfma_f32_16x16x32_bf16 v[60:63], a[44:47], v[40:43], v[60:63]
    s_add_u32 s50, s49, 1024
    s_mul_i32 s50, s50, 49152
    s_waitcnt vmcnt(5)
    buffer_load_dwordx4 a[0:3], v3, s[8:11], s50 offen offset:0 nt
    s_waitcnt vmcnt(5)
    buffer_load_dwordx4 a[4:7], v3, s[8:11], s50 offen offset:128 nt
    s_waitcnt vmcnt(5)
    buffer_load_dwordx4 a[8:11], v3, s[8:11], s50 offen offset:256 nt
    s_waitcnt vmcnt(5)
    buffer_load_dwordx4 a[12:15], v3, s[8:11], s50 offen offset:384 nt
    s_waitcnt vmcnt(5)
    buffer_load_dwordx4 a[16:19], v3, s[8:11], s50 offen offset:512 nt
    s_waitcnt vmcnt(4)
    buffer_load_dwordx4 a[20:23], v3, s[8:11], s50 offen offset:640 nt
    s_waitcnt vmcnt(4)
    buffer_load_dwordx4 a[24:27], v3, s[8:11], s50 offen offset:768 nt
    s_waitcnt vmcnt(4)
    buffer_load_dwordx4 a[28:31], v3, s[8:11], s50 offen offset:896 nt
    s_waitcnt vmcnt(4)
    buffer_load_dwordx4 a[32:35], v3, s[8:11], s50 offen offset:1024 nt
    s_waitcnt vmcnt(4)
    buffer_load_dwordx4 a[36:39], v3, s[8:11], s50 offen offset:1152 nt
    buffer_load_dwordx4 a[40:43], v3, s[8:11], s50 offen offset:1280 nt
    buffer_load_dwordx4 a[44:47], v3, s[8:11], s50 offen offset:1408 nt
    s_add_u32 s50, s49, 1056
    s_mul_i32 s50, s50, 49152
    buffer_load_dword v25, v16, s[8:11], s50 offen nt
    v_lshlrev_b32 v72, 16, v84
    v_and_b32 v73, 0xffff0000, v84
    v_lshlrev_b32 v74, 16, v85
    v_and_b32 v75, 0xffff0000, v85
    v_subrev_f32 v72, s54, v72
    v_subrev_f32 v73, s54, v73
    v_subrev_f32 v74, s54, v74
    v_subrev_f32 v75, s54, v75
    v_mul_f32 v72, 0x3fb8aa3b, v72
    v_mul_f32 v73, 0x3fb8aa3b, v73
    v_mul_f32 v74, 0x3fb8aa3b, v74
    v_mul_f32 v75, 0x3fb8aa3b, v75
    v_exp_f32 v72, v72
    v_exp_f32 v73, v73
    v_exp_f32 v74, v74
    v_exp_f32 v75, v75
    v_mul_f32 v72, v72, v70
    v_mul_f32 v73, v73, v70
    v_mul_f32 v74, v74, v70
    v_mul_f32 v75, v75, v70
    v_cvt_pk_bf16_f32 v72, v72, v72
    v_cvt_pk_bf16_f32 v73, v73, v73
    v_cvt_pk_bf16_f32 v74, v74, v74
    v_cvt_pk_bf16_f32 v75, v75, v75
    v_and_b32 v28, v72, v9
    v_and_b32 v29, v72, v10
    v_and_b32 v30, v72, v11
    v_and_b32 v31, v72, v12
    v_and_b32 v32, v73, v9
    v_and_b32 v33, v73, v10
    v_and_b32 v34, v73, v11
    v_and_b32 v35, v73, v12
    v_and_b32 v36, v74, v9
    v_and_b32 v37, v74, v10
    v_and_b32 v38, v74, v11
    v_and_b32 v39, v74, v12
    v_and_b32 v40, v75, v9
    v_and_b32 v41, v75, v10
    v_and_b32 v42, v75, v11
    v_and_b32 v43, v75, v12
    s_waitcnt vmcnt(23)
    v_mfma_f32_16x16x32_bf16 v[52:55], a[48:51], v[28:31], v[52:55]
    v_mfma_f32_16x16x32_bf16 v[56:59], a[52:55], v[28:31], v[56:59]
    v_mfma_f32_16x16x32_bf16 v[60:63], a[56:59], v[28:31], v[60:63]
    s_waitcnt vmcnt(20)
    v_mfma_f32_16x16x32_bf16 v[52:55], a[60:63], v[32:35], v[52:55]
    v_mfma_f32_16x16x32_bf16 v[56:59], a[64:67], v[32:35], v[56:59]
    v_mfma_f32_16x16x32_bf16 v[60:63], a[68:71], v[32:35], v[60:63]
    s_waitcnt vmcnt(17)
    v_mfma_f32_16x16x32_bf16 v[52:55], a[72:75], v[36:39], v[52:55]
    v_mfma_f32_16x16x32_bf16 v[56:59], a[76:79], v[36:39], v[56:59]
    v_mfma_f32_16x16x32_bf16 v[60:63], a[80:83], v[36:39], v[60:63]
    s_waitcnt vmcnt(14)
    v_mfma_f32_16x16x32_bf16 v[52:55], a[84:87], v[40:43], v[52:55]
    v_mfma_f32_16x16x32_bf16 v[56:59], a[88:91], v[40:43], v[56:59]
    v_mfma_f32_16x16x32_bf16 v[60:63], a[92:95], v[40:43], v[60:63]
    s_add_u32 s50, s49, 1056
    s_mul_i32 s50, s50, 49152
    s_waitcnt vmcnt(5)
    buffer_load_dwordx4 a[48:51], v3, s[8:11], s50 offen offset:0 nt
    s_waitcnt vmcnt(5)
    buffer_load_dwordx4 a[52:55], v3, s[8:11], s50 offen offset:128 nt
    s_waitcnt vmcnt(5)
    buffer_load_dwordx4 a[56:59], v3, s[8:11], s50 offen offset:256 nt
    s_waitcnt vmcnt(5)
    buffer_load_dwordx4 a[60:63], v3, s[8:11], s50 offen offset:384 nt
    s_waitcnt vmcnt(5)
    buffer_load_dwordx4 a[64:67], v3, s[8:11], s50 offen offset:512 nt
    s_waitcnt vmcnt(4)
    buffer_load_dwordx4 a[68:71], v3, s[8:11], s50 offen offset:640 nt
    s_waitcnt vmcnt(4)
    buffer_load_dwordx4 a[72:75], v3, s[8:11], s50 offen offset:768 nt
    s_waitcnt vmcnt(4)
    buffer_load_dwordx4 a[76:79], v3, s[8:11], s50 offen offset:896 nt
    buffer_load_dwordx4 a[80:83], v3, s[8:11], s50 offen offset:1024 nt
    buffer_load_dwordx4 a[84:87], v3, s[8:11], s50 offen offset:1152 nt
    buffer_load_dwordx4 a[88:91], v3, s[8:11], s50 offen offset:1280 nt
    buffer_load_dwordx4 a[92:95], v3, s[8:11], s50 offen offset:1408 nt
    s_add_u32 s50, s49, 1088
    s_mul_i32 s50, s50, 49152
    buffer_load_dword v25, v16, s[8:11], s50 offen nt
    s_mov_b64 exec, s[66:67]
    ds_write_b128 v108, v[52:55] offset:0
    ds_write_b128 v108, v[56:59] offset:256
    ds_write_b128 v108, v[60:63] offset:512
    s_mov_b64 exec, -1
    s_waitcnt lgkmcnt(0)
    s_barrier
    ds_read2st64_b32 v[72:73], v109 offset0:0 offset1:3
    ds_read2st64_b32 v[74:75], v109 offset0:6 offset1:9
    ds_read2st64_b32 v[76:77], v109 offset0:12 offset1:15
    ds_read2st64_b32 v[78:79], v109 offset0:18 offset1:21
    s_waitcnt lgkmcnt(0)
    v_add_f32 v72, v72, v73
    v_add_f32 v74, v74, v75
    v_add_f32 v76, v76, v77
    v_add_f32 v78, v78, v79
    v_add_f32 v72, v72, v74
    v_add_f32 v76, v76, v78
    v_add_f32 v72, v72, v76
    v_cndmask_b32 v72, v72, 4.0, s[70:71]
    ds_write_b32 v110, v72
    v_add_u32 v110, 1024, v110
    v_xor_b32 v108, 8192, v108
    v_xor_b32 v109, 8192, v109
    v_add_u32 v14, 1024, v14
    s_add_u32 s49, s49, 1024
    s_add_u32 s3, s3, 1
    s_cmp_lt_u32 s3, 5
    s_cbranch_scc1 L_sloop_24
    ds_read_b64 v[78:79], v14 offset:0
    ds_read_b64 v[80:81], v14 offset:256
    ds_read_b64 v[82:83], v14 offset:512
    ds_read_b64 v[84:85], v14 offset:768
L_schk_30:
    v_cmp_ne_u32 s[76:77], s57, v106
    s_nop 0
    s_cmp_lg_u64 s[76:77], 0
    s_nop 1
    s_cbranch_scc1 L_sslow_28
L_sback_29:
    v_mov_b32 v68, v104
    s_nop 1
    v_max_f32_dpp v68, v68, v68 quad_perm:[1,0,3,2] row_mask:0xf bank_mask:0xf
    s_nop 1
    v_max_f32_dpp v68, v68, v68 quad_perm:[2,3,0,1] row_mask:0xf bank_mask:0xf
    s_nop 1
    v_max_f32_dpp v68, v68, v68 row_half_mirror row_mask:0xf bank_mask:0xf
    s_nop 1
    v_max_f32_dpp v68, v68, v68 row_mirror row_mask:0xf bank_mask:0xf
    s_nop 1
    v_max_f32_dpp v68, v68, v68 row_bcast:15 row_mask:0xa bank_mask:0xf
    s_nop 0
    v_readlane_b32 s54, v68, 31
    s_nop 1
    v_subrev_f32 v69, s54, v104
    v_mul_f32 v69, 0x3fb8aa3b, v69
    v_exp_f32 v69, v69
    s_nop 0
    v_mul_f32 v69, v69, v105
    s_nop 1
    v_add_f32_dpp v69, v69, v69 quad_perm:[1,0,3,2] row_mask:0xf bank_mask:0xf
    s_nop 1
    v_add_f32_dpp v69, v69, v69 quad_perm:[2,3,0,1] row_mask:0xf bank_mask:0xf
    s_nop 1
    v_add_f32_dpp v69, v69, v69 row_half_mirror row_mask:0xf bank_mask:0xf
    s_nop 1
    v_add_f32_dpp v69, v69, v69 row_mirror row_mask:0xf bank_mask:0xf
    s_nop 1
    v_add_f32_dpp v69, v69, v69 row_bcast:15 row_mask:0xa bank_mask:0xf
    s_nop 0
    v_readlane_b32 s55, v69, 31
    s_nop 1
    v_rcp_f32 v70, s55
    v_mov_b32 v22, 1
    s_add_u32 s53, s61, 0
    s_and_b32 s53, s53, 7
    s_mul_i32 s53, s53, 1280
    s_add_u32 s53, s53, s63
    s_cmp_ge_u32 s82, 8192
    s_cselect_b32 s53, 2146435072, s53
    buffer_atomic_add v22, v16, s[12:15], s53 offen sc0 sc1
    v_mov_b32 v23, 1
    s_add_u32 s53, s61, 1
    s_and_b32 s53, s53, 7
    s_mul_i32 s53, s53, 1280
    s_add_u32 s53, s53, s63
    s_cmp_ge_u32 s83, 8192
    s_cselect_b32 s53, 2146435072, s53
    buffer_atomic_add v23, v16, s[12:15], s53 offen sc0 sc1
    s_waitcnt lgkmcnt(0)
    v_lshlrev_b32 v72, 16, v78
    v_and_b32 v73, 0xffff0000, v78
    v_lshlrev_b32 v74, 16, v79
    v_and_b32 v75, 0xffff0000, v79
    v_subrev_f32 v72, s54, v72
    v_subrev_f32 v73, s54, v73
    v_subrev_f32 v74, s54, v74
    v_subrev_f32 v75, s54, v75
    v_mul_f32 v72, 0x3fb8aa3b, v72
    v_mul_f32 v73, 0x3fb8aa3b, v73
    v_mul_f32 v74, 0x3fb8aa3b, v74
    v_mul_f32 v75, 0x3fb8aa3b, v75
    v_exp_f32 v72, v72
    v_exp_f32 v73, v73
    v_exp_f32 v74, v74
    v_exp_f32 v75, v75
    v_mul_f32 v72, v72, v70
    v_mul_f32 v73, v73, v70
    v_mul_f32 v74, v74, v70
    v_mul_f32 v75, v75, v70
    v_cvt_pk_bf16_f32 v72, v72, v72
    v_cvt_pk_bf16_f32 v73, v73, v73
    v_cvt_pk_bf16_f32 v74, v74, v74
    v_cvt_pk_bf16_f32 v75, v75, v75
    v_and_b32 v28, v72, v9
    v_and_b32 v29, v72, v10
    v_and_b32 v30, v72, v11
    v_and_b32 v31, v72, v12
    v_and_b32 v32, v73, v9
    v_and_b32 v33, v73, v10
    v_and_b32 v34, v73, v11
    v_and_b32 v35, v73, v12
    v_and_b32 v36, v74, v9
    v_and_b32 v37, v74, v10
    v_and_b32 v38, v74, v11
    v_and_b32 v39, v74, v12
    v_and_b32 v40, v75, v9
    v_and_b32 v41, v75, v10
    v_and_b32 v42, v75, v11
    v_and_b32 v43, v75, v12
    v_mfma_f32_16x16x32_bf16 v[52:55], a[0:3], v[28:31], 0
    v_mfma_f32_16x16x32_bf16 v[56:59], a[4:7], v[28:31], 0
    v_mfma_f32_16x16x32_bf16 v[60:63], a[8:11], v[28:31], 0
    v_mfma_f32_16x16x32_bf16 v[52:55], a[12:15], v[32:35], v[52:55]
    v_mfma_f32_16x16x32_bf16 v[56:59], a[16:19], v[32:35], v[56:59]
    v_mfma_f32_16x16x32_bf16 v[60:63], a[20:23], v[32:35], v[60:63]
    v_mfma_f32_16x16x32_bf16 v[52:55], a[24:27], v[36:39], v[52:55]
    v_mfma_f32_16x16x32_bf16 v[56:59], a[28:31], v[36:39], v[56:59]
    v_mfma_f32_16x16x32_bf16 v[60:63], a[32:35], v[36:39], v[60:63]
    v_mfma_f32_16x16x32_bf16 v[52:55], a[36:39], v[40:43], v[52:55]
    v_mfma_f32_16x16x32_bf16 v[56:59], a[40:43], v[40:43], v[56:59]
    v_mfma_f32_16x16x32_bf16 v[60:63], a[44:47], v[40:43], v[60:63]
    s_add_u32 s50, s49, 64
    s_mul_i32 s50, s50, 49152
    s_waitcnt vmcnt(7)
    buffer_load_dwordx4 a[0:3], v3, s[8:11], s50 offen offset:0 nt
    s_waitcnt vmcnt(7)
    buffer_load_dwordx4 a[4:7], v3, s[8:11], s50 offen offset:128 nt
    s_waitcnt vmcnt(7)
    buffer_load_dwordx4 a[8:11], v3, s[8:11], s50 offen offset:256 nt
    s_waitcnt vmcnt(7)
    buffer_load_dwordx4 a[12:15], v3, s[8:11], s50 offen offset:384 nt
    s_waitcnt vmcnt(7)
    buffer_load_dwordx4 a[16:19], v3, s[8:11], s50 offen offset:512 nt
    s_waitcnt vmcnt(4)
    buffer_load_dwordx4 a[20:23], v3, s[8:11], s50 offen offset:640 nt
    s_waitcnt vmcnt(4)
    buffer_load_dwordx4 a[24:27], v3, s[8:11], s50 offen offset:768 nt
    s_waitcnt vmcnt(4)
    buffer_load_dwordx4 a[28:31], v3, s[8:11], s50 offen offset:896 nt
    s_waitcnt vmcnt(4)
    buffer_load_dwordx4 a[32:35], v3, s[8:11], s50 offen offset:1024 nt
    s_waitcnt vmcnt(4)
    buffer_load_dwordx4 a[36:39], v3, s[8:11], s50 offen offset:1152 nt
    buffer_load_dwordx4 a[40:43], v3, s[8:11], s50 offen offset:1280 nt
    buffer_load_dwordx4 a[44:47], v3, s[8:11], s50 offen offset:1408 nt
    s_add_u32 s50, s49, 96
    s_mul_i32 s50, s50, 49152
    buffer_load_dword v25, v16, s[8:11], s50 offen nt
    v_lshlrev_b32 v72, 16, v80
    v_and_b32 v73, 0xffff0000, v80
    v_lshlrev_b32 v74, 16, v81
    v_and_b32 v75, 0xffff0000, v81
    v_subrev_f32 v72, s54, v72
    v_subrev_f32 v73, s54, v73
    v_subrev_f32 v74, s54, v74
    v_subrev_f32 v75, s54, v75
    v_mul_f32 v72, 0x3fb8aa3b, v72
    v_mul_f32 v73, 0x3fb8aa3b, v73
    v_mul_f32 v74, 0x3fb8aa3b, v74
    v_mul_f32 v75, 0x3fb8aa3b, v75
    v_exp_f32 v72, v72
    v_exp_f32 v73, v73
    v_exp_f32 v74, v74
    v_exp_f32 v75, v75
    v_mul_f32 v72, v72, v70
    v_mul_f32 v73, v73, v70
    v_mul_f32 v74, v74, v70
    v_mul_f32 v75, v75, v70
    v_cvt_pk_bf16_f32 v72, v72, v72
    v_cvt_pk_bf16_f32 v73, v73, v73
    v_cvt_pk_bf16_f32 v74, v74, v74
    v_cvt_pk_bf16_f32 v75, v75, v75
    v_and_b32 v28, v72, v9
    v_and_b32 v29, v72, v10
    v_and_b32 v30, v72, v11
    v_and_b32 v31, v72, v12
    v_and_b32 v32, v73, v9
    v_and_b32 v33, v73, v10
    v_and_b32 v34, v73, v11
    v_and_b32 v35, v73, v12
    v_and_b32 v36, v74, v9
    v_and_b32 v37, v74, v10
    v_and_b32 v38, v74, v11
    v_and_b32 v39, v74, v12
    v_and_b32 v40, v75, v9
    v_and_b32 v41, v75, v10
    v_and_b32 v42, v75, v11
    v_and_b32 v43, v75, v12
    v_mfma_f32_16x16x32_bf16 v[52:55], a[48:51], v[28:31], v[52:55]
    v_mfma_f32_16x16x32_bf16 v[56:59], a[52:55], v[28:31], v[56:59]
    v_mfma_f32_16x16x32_bf16 v[60:63], a[56:59], v[28:31], v[60:63]
    v_mfma_f32_16x16x32_bf16 v[52:55], a[60:63], v[32:35], v[52:55]
    v_mfma_f32_16x16x32_bf16 v[56:59], a[64:67], v[32:35], v[56:59]
    v_mfma_f32_16x16x32_bf16 v[60:63], a[68:71], v[32:35], v[60:63]
    v_mfma_f32_16x16x32_bf16 v[52:55], a[72:75], v[36:39], v[52:55]
    v_mfma_f32_16x16x32_bf16 v[56:59], a[76:79], v[36:39], v[56:59]
    v_mfma_f32_16x16x32_bf16 v[60:63], a[80:83], v[36:39], v[60:63]
    v_mfma_f32_16x16x32_bf16 v[52:55], a[84:87], v[40:43], v[52:55]
    v_mfma_f32_16x16x32_bf16 v[56:59], a[88:91], v[40:43], v[56:59]
    v_mfma_f32_16x16x32_bf16 v[60:63], a[92:95], v[40:43], v[60:63]
    s_add_u32 s50, s49, 96
    s_mul_i32 s50, s50, 49152
    s_waitcnt vmcnt(5)
    buffer_load_dwordx4 a[48:51], v3, s[8:11], s50 offen offset:0 nt
    s_waitcnt vmcnt(5)
    buffer_load_dwordx4 a[52:55], v3, s[8:11], s50 offen offset:128 nt
    s_waitcnt vmcnt(5)
    buffer_load_dwordx4 a[56:59], v3, s[8:11], s50 offen offset:256 nt
    s_waitcnt vmcnt(5)
    buffer_load_dwordx4 a[60:63], v3, s[8:11], s50 offen offset:384 nt
    s_waitcnt vmcnt(5)
    buffer_load_dwordx4 a[64:67], v3, s[8:11], s50 offen offset:512 nt
    s_waitcnt vmcnt(4)
    buffer_load_dwordx4 a[68:71], v3, s[8:11], s50 offen offset:640 nt
    s_waitcnt vmcnt(4)
    buffer_load_dwordx4 a[72:75], v3, s[8:11], s50 offen offset:768 nt
    s_waitcnt vmcnt(4)
    buffer_load_dwordx4 a[76:79], v3, s[8:11], s50 offen offset:896 nt
    s_waitcnt vmcnt(4)
    buffer_load_dwordx4 a[80:83], v3, s[8:11], s50 offen offset:1024 nt
    s_waitcnt vmcnt(4)
    buffer_load_dwordx4 a[84:87], v3, s[8:11], s50 offen offset:1152 nt
    buffer_load_dwordx4 a[88:91], v3, s[8:11], s50 offen offset:1280 nt
    buffer_load_dwordx4 a[92:95], v3, s[8:11], s50 offen offset:1408 nt
    s_add_u32 s50, s49, 1024
    s_mul_i32 s50, s50, 49152
    buffer_load_dword v25, v16, s[8:11], s50 offen nt
    v_cmp_eq_u32 vcc, 0, v0
    s_nop 0
    s_mov_b64 exec, vcc
    ds_write_b32 v113, v22 offset:34320
    ds_write_b32 v113, v23 offset:34324
    s_mov_b64 exec, -1
    s_waitcnt lgkmcnt(0)
    s_barrier
    ds_read_b64 v[68:69], v113 offset:34320
    s_waitcnt lgkmcnt(0)
    v_readfirstlane_b32 s59, v68
    v_readfirstlane_b32 s23, v69
    v_lshlrev_b32 v72, 16, v82
    v_and_b32 v73, 0xffff0000, v82
    v_lshlrev_b32 v74, 16, v83
    v_and_b32 v75, 0xffff0000, v83
    v_subrev_f32 v72, s54, v72
    v_subrev_f32 v73, s54, v73
    v_subrev_f32 v74, s54, v74
    v_subrev_f32 v75, s54, v75
    v_mul_f32 v72, 0x3fb8aa3b, v72
    v_mul_f32 v73, 0x3fb8aa3b, v73
    v_mul_f32 v74, 0x3fb8aa3b, v74
    v_mul_f32 v75, 0x3fb8aa3b, v75
    v_exp_f32 v72, v72
    v_exp_f32 v73, v73
    v_exp_f32 v74, v74
    v_exp_f32 v75, v75
    v_mul_f32 v72, v72, v70
    v_mul_f32 v73, v73, v70
    v_mul_f32 v74, v74, v70
    v_mul_f32 v75, v75, v70
    v_cvt_pk_bf16_f32 v72, v72, v72
    v_cvt_pk_bf16_f32 v73, v73, v73
    v_cvt_pk_bf16_f32 v74, v74, v74
    v_cvt_pk_bf16_f32 v75, v75, v75
    v_and_b32 v28, v72, v9
    v_and_b32 v29, v72, v10
    v_and_b32 v30, v72, v11
    v_and_b32 v31, v72, v12
    v_and_b32 v32, v73, v9
    v_and_b32 v33, v73, v10
    v_and_b32 v34, v73, v11
    v_and_b32 v35, v73, v12
    v_and_b32 v36, v74, v9
    v_and_b32 v37, v74, v10
    v_and_b32 v38, v74, v11
    v_and_b32 v39, v74, v12
    v_and_b32 v40, v75, v9
    v_and_b32 v41, v75, v10
    v_and_b32 v42, v75, v11
    v_and_b32 v43, v75, v12
    v_mfma_f32_16x16x32_bf16 v[52:55], a[0:3], v[28:31], v[52:55]
    v_mfma_f32_16x16x32_bf16 v[56:59], a[4:7], v[28:31], v[56:59]
    v_mfma_f32_16x16x32_bf16 v[60:63], a[8:11], v[28:31], v[60:63]
    v_mfma_f32_16x16x32_bf16 v[52:55], a[12:15], v[32:35], v[52:55]
    v_mfma_f32_16x16x32_bf16 v[56:59], a[16:19], v[32:35], v[56:59]
    v_mfma_f32_16x16x32_bf16 v[60:63], a[20:23], v[32:35], v[60:63]
    v_mfma_f32_16x16x32_bf16 v[52:55], a[24:27], v[36:39], v[52:55]
    v_mfma_f32_16x16x32_bf16 v[56:59], a[28:31], v[36:39], v[56:59]
    v_mfma_f32_16x16x32_bf16 v[60:63], a[32:35], v[36:39], v[60:63]
    v_mfma_f32_16x16x32_bf16 v[52:55], a[36:39], v[40:43], v[52:55]
    v_mfma_f32_16x16x32_bf16 v[56:59], a[40:43], v[40:43], v[56:59]
    v_mfma_f32_16x16x32_bf16 v[60:63], a[44:47], v[40:43], v[60:63]
    s_add_u32 s50, s61, 0
    s_and_b32 s50, s50, 7
    s_mul_i32 s51, s59, 8
    s_add_u32 s51, s51, s50
    s_add_u32 s51, s51, 6144
    s_cmp_ge_u32 s82, 8192
    s_cselect_b32 s82, s82, s51
    s_cmp_ge_u32 s58, s56
    s_cselect_b32 s82, 0x100000, s82
    s_add_u32 s50, s58, 2
    s_cmp_ge_u32 s82, s86
    s_cselect_b32 s50, s50, s56
    s_cselect_b32 s63, 2146435072, s63
    s_min_u32 s56, s56, s50
    s_add_u32 s58, s58, 1
    s_lshr_b32 s51, s82, 7
    s_lshl_b32 s51, s51, 9
    s_add_u32 s51, s51, 786432
    s_lshl_b32 s52, s82, 9
    s_add_u32 s52, s52, 1048576
    s_cmp_lt_u32 s82, 8192
    s_cselect_b32 s51, s51, 2146435072
    s_cselect_b32 s52, s52, 2146435072
    s_mul_i32 s50, s82, 49152
    s_cselect_b32 s50, s50, 2146435072
    buffer_load_dwordx4 v[88:91], v24, s[12:15], s51 offen sc1
    buffer_load_dwordx4 v[92:95], v18, s[12:15], s52 offen sc1
    buffer_load_dwordx4 a[0:3], v3, s[8:11], s50 offen offset:0 nt
    s_waitcnt vmcnt(10)
    buffer_load_dwordx4 a[4:7], v3, s[8:11], s50 offen offset:128 nt
    s_waitcnt vmcnt(10)
    buffer_load_dwordx4 a[8:11], v3, s[8:11], s50 offen offset:256 nt
    s_waitcnt vmcnt(10)
    buffer_load_dwordx4 a[12:15], v3, s[8:11], s50 offen offset:384 nt
    s_waitcnt vmcnt(10)
    buffer_load_dwordx4 a[16:19], v3, s[8:11], s50 offen offset:512 nt
    s_waitcnt vmcnt(10)
    buffer_load_dwordx4 a[20:23], v3, s[8:11], s50 offen offset:640 nt
    s_waitcnt vmcnt(10)
    buffer_load_dwordx4 a[24:27], v3, s[8:11], s50 offen offset:768 nt
    s_waitcnt vmcnt(10)
    buffer_load_dwordx4 a[28:31], v3, s[8:11], s50 offen offset:896 nt
    s_waitcnt vmcnt(7)
    buffer_load_dwordx4 a[32:35], v3, s[8:11], s50 offen offset:1024 nt
    s_waitcnt vmcnt(7)
    buffer_load_dwordx4 a[36:39], v3, s[8:11], s50 offen offset:1152 nt
    s_waitcnt vmcnt(7)
    buffer_load_dwordx4 a[40:43], v3, s[8:11], s50 offen offset:1280 nt
    s_waitcnt vmcnt(7)
    buffer_load_dwordx4 a[44:47], v3, s[8:11], s50 offen offset:1408 nt
    v_mov_b32 v22, 1
    s_add_u32 s53, s61, 0
    s_and_b32 s53, s53, 7
    s_mul_i32 s53, s53, 1280
    s_add_u32 s53, s53, s63
    s_cmp_ge_u32 s82, 8192
    s_cselect_b32 s53, 2146435072, s53
    buffer_atomic_add v22, v16, s[12:15], s53 offen sc0 sc1
    v_lshlrev_b32 v72, 16, v84
    v_and_b32 v73, 0xffff0000, v84
    v_lshlrev_b32 v74, 16, v85
    v_and_b32 v75, 0xffff0000, v85
    v_subrev_f32 v72, s54, v72
    v_subrev_f32 v73, s54, v73
    v_subrev_f32 v74, s54, v74
    v_subrev_f32 v75, s54, v75
    v_mul_f32 v72, 0x3fb8aa3b, v72
    v_mul_f32 v73, 0x3fb8aa3b, v73
    v_mul_f32 v74, 0x3fb8aa3b, v74
    v_mul_f32 v75, 0x3fb8aa3b, v75
    v_exp_f32 v72, v72
    v_exp_f32 v73, v73
    v_exp_f32 v74, v74
    v_exp_f32 v75, v75
    v_mul_f32 v72, v72, v70
    v_mul_f32 v73, v73, v70
    v_mul_f32 v74, v74, v70
    v_mul_f32 v75, v75, v70
    v_cvt_pk_bf16_f32 v72, v72, v72
    v_cvt_pk_bf16_f32 v73, v73, v73
    v_cvt_pk_bf16_f32 v74, v74, v74
    v_cvt_pk_bf16_f32 v75, v75, v75
    v_and_b32 v28, v72, v9
    v_and_b32 v29, v72, v10
    v_and_b32 v30, v72, v11
    v_and_b32 v31, v72, v12
    v_and_b32 v32, v73, v9
    v_and_b32 v33, v73, v10
    v_and_b32 v34, v73, v11
    v_and_b32 v35, v73, v12
    v_and_b32 v36, v74, v9
    v_and_b32 v37, v74, v10
    v_and_b32 v38, v74, v11
    v_and_b32 v39, v74, v12
    v_and_b32 v40, v75, v9
    v_and_b32 v41, v75, v10
    v_and_b32 v42, v75, v11
    v_and_b32 v43, v75, v12
    v_mfma_f32_16x16x32_bf16 v[52:55], a[48:51], v[28:31], v[52:55]
    v_mfma_f32_16x16x32_bf16 v[56:59], a[52:55], v[28:31], v[56:59]
    v_mfma_f32_16x16x32_bf16 v[60:63], a[56:59], v[28:31], v[60:63]
    v_mfma_f32_16x16x32_bf16 v[52:55], a[60:63], v[32:35], v[52:55]
    v_mfma_f32_16x16x32_bf16 v[56:59], a[64:67], v[32:35], v[56:59]
    v_mfma_f32_16x16x32_bf16 v[60:63], a[68:71], v[32:35], v[60:63]
    v_mfma_f32_16x16x32_bf16 v[52:55], a[72:75], v[36:39], v[52:55]
    v_mfma_f32_16x16x32_bf16 v[56:59], a[76:79], v[36:39], v[56:59]
    v_mfma_f32_16x16x32_bf16 v[60:63], a[80:83], v[36:39], v[60:63]
    v_mfma_f32_16x16x32_bf16 v[52:55], a[84:87], v[40:43], v[52:55]
    v_mfma_f32_16x16x32_bf16 v[56:59], a[88:91], v[40:43], v[56:59]
    v_mfma_f32_16x16x32_bf16 v[60:63], a[92:95], v[40:43], v[60:63]
    s_mov_b32 s59, s23
    s_add_u32 s50, s61, 1
    s_and_b32 s50, s50, 7
    s_mul_i32 s51, s59, 8
    s_add_u32 s51, s51, s50
    s_add_u32 s51, s51, 6144
    s_cmp_ge_u32 s83, 8192
    s_cselect_b32 s83, s83, s51
    s_cmp_ge_u32 s58, s56
    s_cselect_b32 s83, 0x100000, s83
    s_add_u32 s50, s58, 2
    s_cmp_ge_u32 s83, s86
    s_cselect_b32 s50, s50, s56
    s_cselect_b32 s63, 2146435072, s63
    s_min_u32 s56, s56, s50
    s_add_u32 s58, s58, 1
    s_lshr_b32 s51, s83, 7
    s_lshl_b32 s51, s51, 9
    s_add_u32 s51, s51, 786432
    s_lshl_b32 s52, s83, 9
    s_add_u32 s52, s52, 1048576
    s_cmp_lt_u32 s83, 8192
    s_cselect_b32 s51, s51, 2146435072
    s_cselect_b32 s52, s52, 2146435072
    s_mul_i32 s50, s83, 49152
    s_cselect_b32 s50, s50, 2146435072
    buffer_load_dwordx4 v[96:99], v24, s[12:15], s51 offen sc1
    buffer_load_dwordx4 v[100:103], v18, s[12:15], s52 offen sc1
    s_waitcnt vmcnt(10)
    buffer_load_dwordx4 a[48:51], v3, s[8:11], s50 offen offset:0 nt
    s_waitcnt vmcnt(10)
    buffer_load_dwordx4 a[52:55], v3, s[8:11], s50 offen offset:128 nt
    s_waitcnt vmcnt(10)
    buffer_load_dwordx4 a[56:59], v3, s[8:11], s50 offen offset:256 nt
    s_waitcnt vmcnt(10)
    buffer_load_dwordx4 a[60:63], v3, s[8:11], s50 offen offset:384 nt
    s_waitcnt vmcnt(10)
    buffer_load_dwordx4 a[64:67], v3, s[8:11], s50 offen offset:512 nt
    s_waitcnt vmcnt(10)
    buffer_load_dwordx4 a[68:71], v3, s[8:11], s50 offen offset:640 nt
    s_waitcnt vmcnt(10)
    buffer_load_dwordx4 a[72:75], v3, s[8:11], s50 offen offset:768 nt
    s_waitcnt vmcnt(10)
    buffer_load_dwordx4 a[76:79], v3, s[8:11], s50 offen offset:896 nt
    s_waitcnt vmcnt(7)
    buffer_load_dwordx4 a[80:83], v3, s[8:11], s50 offen offset:1024 nt
    s_waitcnt vmcnt(7)
    buffer_load_dwordx4 a[84:87], v3, s[8:11], s50 offen offset:1152 nt
    s_waitcnt vmcnt(7)
    buffer_load_dwordx4 a[88:91], v3, s[8:11], s50 offen offset:1280 nt
    s_waitcnt vmcnt(7)
    buffer_load_dwordx4 a[92:95], v3, s[8:11], s50 offen offset:1408 nt
    v_mov_b32 v23, 1
    s_add_u32 s53, s61, 1
    s_and_b32 s53, s53, 7
    s_mul_i32 s53, s53, 1280
    s_add_u32 s53, s53, s63
    s_cmp_ge_u32 s83, 8192
    s_cselect_b32 s53, 2146435072, s53
    buffer_atomic_add v23, v16, s[12:15], s53 offen sc0 sc1
    s_mov_b64 exec, s[66:67]
    ds_write_b128 v108, v[52:55] offset:0
    ds_write_b128 v108, v[56:59] offset:256
    ds_write_b128 v108, v[60:63] offset:512
    s_mov_b64 exec, -1
    v_mov_b32 v68, 0
    v_cmp_eq_u32 vcc, 0, v0
    s_nop 0
    s_mov_b64 exec, vcc
    ds_write_b32 v68, v22 offset:34312
    s_mov_b64 exec, -1
    s_waitcnt lgkmcnt(0)
    s_barrier
    ds_read2st64_b32 v[72:73], v109 offset0:0 offset1:3
    ds_read2st64_b32 v[74:75], v109 offset0:6 offset1:9
    ds_read2st64_b32 v[76:77], v109 offset0:12 offset1:15
    ds_read2st64_b32 v[78:79], v109 offset0:18 offset1:21
    ds_read_b32 v69, v68 offset:34312
    s_lshr_b32 s50, s49, 7
    s_mul_i32 s50, s50, 4
    s_bfe_u32 s51, s49, 131074
    s_add_u32 s50, s50, s51
    s_lshl_b32 s50, s50, 10
    s_add_u32 s50, s50, 6291456
    s_cmp_ge_u32 s49, 8192
    s_cselect_b32 s50, 2146435072, s50
    s_waitcnt lgkmcnt(0)
    v_readfirstlane_b32 s59, v69
    v_add_f32 v72, v72, v73
    v_add_f32 v74, v74, v75
    v_add_f32 v76, v76, v77
    v_add_f32 v78, v78, v79
    v_add_f32 v72, v72, v74
    v_add_f32 v76, v76, v78
    v_add_f32 v72, v72, v76
    v_cndmask_b32 v72, v72, 4.0, s[70:71]
    buffer_atomic_add_f32 v72, v21, s[12:15], s50 offen sc1
    ds_read_b32 v76, v21 offset:55040
    ds_read_b32 v77, v21 offset:56064
    ds_read_b32 v78, v21 offset:57088
    ds_read_b32 v79, v21 offset:58112
    ds_read_b32 v80, v21 offset:59136
    s_sub_u32 s50, s50, 32768
    s_waitcnt lgkmcnt(0)
    buffer_atomic_add_f32 v80, v21, s[12:15], s50 offen sc1
    s_sub_u32 s50, s50, 32768
    buffer_atomic_add_f32 v79, v21, s[12:15], s50 offen sc1
    s_sub_u32 s50, s50, 32768
    buffer_atomic_add_f32 v78, v21, s[12:15], s50 offen sc1
    s_sub_u32 s50, s50, 32768
    buffer_atomic_add_f32 v77, v21, s[12:15], s50 offen sc1
    s_sub_u32 s50, s50, 32768
    buffer_atomic_add_f32 v76, v21, s[12:15], s50 offen sc1
    v_xor_b32 v108, 8192, v108
    v_xor_b32 v109, 8192, v109
    v_add_u32 v14, 1024, v14
    s_add_u32 s49, s49, 1024
.p2align 6
L_vloop_31:
    s_min_u32 s50, s82, s83
    s_cmp_ge_u32 s50, 8192
    s_cbranch_scc1 L_exit_12
    s_mov_b32 s49, s82
    s_waitcnt vmcnt(30)
L_vchk_34:
    v_cmp_ne_u32 s[76:77], s57, v90
    v_cmp_ne_u32 s[78:79], s57, v94
    s_nop 0
    s_or_b64 s[76:77], s[76:77], s[78:79]
    s_nop 1
    s_cbranch_scc1 L_vslow_32
L_vback_33:
    v_mov_b32 v68, v88
    s_nop 1
    v_max_f32_dpp v68, v68, v68 quad_perm:[1,0,3,2] row_mask:0xf bank_mask:0xf
    s_nop 1
    v_max_f32_dpp v68, v68, v68 quad_perm:[2,3,0,1] row_mask:0xf bank_mask:0xf
    s_nop 1
    v_max_f32_dpp v68, v68, v68 row_half_mirror row_mask:0xf bank_mask:0xf
    s_nop 1
    v_max_f32_dpp v68, v68, v68 row_mirror row_mask:0xf bank_mask:0xf
    s_nop 1
    v_max_f32_dpp v68, v68, v68 row_bcast:15 row_mask:0xa bank_mask:0xf
    s_nop 0
    v_readlane_b32 s54, v68, 31
    s_nop 1
    v_subrev_f32 v69, s54, v88
    v_mul_f32 v69, 0x3fb8aa3b, v69
    v_exp_f32 v69, v69
    s_nop 0
    v_mul_f32 v69, v69, v89
    s_nop 1
    v_add_f32_dpp v69, v69, v69 quad_perm:[1,0,3,2] row_mask:0xf bank_mask:0xf
    s_nop 1
    v_add_f32_dpp v69, v69, v69 quad_perm:[2,3,0,1] row_mask:0xf bank_mask:0xf
    s_nop 1
    v_add_f32_dpp v69, v69, v69 row_half_mirror row_mask:0xf bank_mask:0xf
    s_nop 1
    v_add_f32_dpp v69, v69, v69 row_mirror row_mask:0xf bank_mask:0xf
    s_nop 1
    v_add_f32_dpp v69, v69, v69 row_bcast:15 row_mask:0xa bank_mask:0xf
    s_nop 0
    v_readlane_b32 s55, v69, 31
    s_nop 1
    v_rcp_f32 v70, s55
    v_lshlrev_b32 v72, 16, v92
    v_and_b32 v73, 0xffff0000, v92
    v_lshlrev_b32 v74, 16, v93
    v_and_b32 v75, 0xffff0000, v93
    v_subrev_f32 v72, s54, v72
    v_subrev_f32 v73, s54, v73
    v_subrev_f32 v74, s54, v74
    v_subrev_f32 v75, s54, v75
    v_mul_f32 v72, 0x3fb8aa3b, v72
    v_mul_f32 v73, 0x3fb8aa3b, v73
    v_mul_f32 v74, 0x3fb8aa3b, v74
    v_mul_f32 v75, 0x3fb8aa3b, v75
    v_exp_f32 v72, v72
    v_exp_f32 v73, v73
    v_exp_f32 v74, v74
    v_exp_f32 v75, v75
    v_mul_f32 v72, v72, v70
    v_mul_f32 v73, v73, v70
    v_mul_f32 v74, v74, v70
    v_mul_f32 v75, v75, v70
    v_cvt_pk_bf16_f32 v72, v72, v72
    v_cvt_pk_bf16_f32 v73, v73, v73
    v_cvt_pk_bf16_f32 v74, v74, v74
    v_cvt_pk_bf16_f32 v75, v75, v75
    v_and_b32 v28, v72, v9
    v_and_b32 v29, v72, v10
    v_and_b32 v30, v72, v11
    v_and_b32 v31, v72, v12
    v_and_b32 v32, v73, v9
    v_and_b32 v33, v73, v10
    v_and_b32 v34, v73, v11
    v_and_b32 v35, v73, v12
    v_and_b32 v36, v74, v9
    v_and_b32 v37, v74, v10
    v_and_b32 v38, v74, v11
    v_and_b32 v39, v74, v12
    v_and_b32 v40, v75, v9
    v_and_b32 v41, v75, v10
    v_and_b32 v42, v75, v11
    v_and_b32 v43, v75, v12
    s_waitcnt vmcnt(27)
    v_mfma_f32_16x16x32_bf16 v[52:55], a[0:3], v[28:31], 0
    v_mfma_f32_16x16x32_bf16 v[56:59], a[4:7], v[28:31], 0
    v_mfma_f32_16x16x32_bf16 v[60:63], a[8:11], v[28:31], 0
    s_waitcnt vmcnt(24)
    v_mfma_f32_16x16x32_bf16 v[52:55], a[12:15], v[32:35], v[52:55]
    v_mfma_f32_16x16x32_bf16 v[56:59], a[16:19], v[32:35], v[56:59]
    v_mfma_f32_16x16x32_bf16 v[60:63], a[20:23], v[32:35], v[60:63]
    s_waitcnt vmcnt(21)
    v_mfma_f32_16x16x32_bf16 v[52:55], a[24:27], v[36:39], v[52:55]
    v_mfma_f32_16x16x32_bf16 v[56:59], a[28:31], v[36:39], v[56:59]
    v_mfma_f32_16x16x32_bf16 v[60:63], a[32:35], v[36:39], v[60:63]
    s_waitcnt vmcnt(18)
    v_mfma_f32_16x16x32_bf16 v[52:55], a[36:39], v[40:43], v[52:55]
    v_mfma_f32_16x16x32_bf16 v[56:59], a[40:43], v[40:43], v[56:59]
    v_mfma_f32_16x16x32_bf16 v[60:63], a[44:47], v[40:43], v[60:63]
    s_add_u32 s50, s61, 0
    s_and_b32 s50, s50, 7
    s_mul_i32 s51, s59, 8
    s_add_u32 s51, s51, s50
    s_add_u32 s51, s51, 6144
    s_cmp_ge_u32 s82, 8192
    s_cselect_b32 s82, s82, s51
    s_cmp_ge_u32 s58, s56
    s_cselect_b32 s82, 0x100000, s82
    s_add_u32 s50, s58, 2
    s_cmp_ge_u32 s82, s86
    s_cselect_b32 s50, s50, s56
    s_cselect_b32 s63, 2146435072, s63
    s_min_u32 s56, s56, s50
    s_add_u32 s58, s58, 1
    s_min_u32 s50, s82, s83
    s_cmp_ge_u32 s50, 8192
    s_cbranch_scc1 L_nold_35
    s_lshr_b32 s51, s82, 7
    s_lshl_b32 s51, s51, 9
    s_add_u32 s51, s51, 786432
    s_lshl_b32 s52, s82, 9
    s_add_u32 s52, s52, 1048576
    s_cmp_lt_u32 s82, 8192
    s_cselect_b32 s51, s51, 2146435072
    s_cselect_b32 s52, s52, 2146435072
    s_mul_i32 s50, s82, 49152
    s_cselect_b32 s50, s50, 2146435072
    buffer_load_dwordx4 v[88:91], v24, s[12:15], s51 offen sc1
    buffer_load_dwordx4 v[92:95], v18, s[12:15], s52 offen sc1
    s_waitcnt vmcnt(11)
    buffer_load_dwordx4 a[0:3], v3, s[8:11], s50 offen offset:0 nt
    s_waitcnt vmcnt(11)
    buffer_load_dwordx4 a[4:7], v3, s[8:11], s50 offen offset:128 nt
    s_waitcnt vmcnt(11)
    buffer_load_dwordx4 a[8:11], v3, s[8:11], s50 offen offset:256 nt
    s_waitcnt vmcnt(11)
    buffer_load_dwordx4 a[12:15], v3, s[8:11], s50 offen offset:384 nt
    s_waitcnt vmcnt(11)
    buffer_load_dwordx4 a[16:19], v3, s[8:11], s50 offen offset:512 nt
    s_waitcnt vmcnt(11)
    buffer_load_dwordx4 a[20:23], v3, s[8:11], s50 offen offset:640 nt
    s_waitcnt vmcnt(11)
    buffer_load_dwordx4 a[24:27], v3, s[8:11], s50 offen offset:768 nt
    s_waitcnt vmcnt(11)
    buffer_load_dwordx4 a[28:31], v3, s[8:11], s50 offen offset:896 nt
    s_waitcnt vmcnt(7)
    buffer_load_dwordx4 a[32:35], v3, s[8:11], s50 offen offset:1024 nt
    s_waitcnt vmcnt(7)
    buffer_load_dwordx4 a[36:39], v3, s[8:11], s50 offen offset:1152 nt
    s_waitcnt vmcnt(7)
    buffer_load_dwordx4 a[40:43], v3, s[8:11], s50 offen offset:1280 nt
    s_waitcnt vmcnt(7)
    buffer_load_dwordx4 a[44:47], v3, s[8:11], s50 offen offset:1408 nt
L_nold_35:
    s_mov_b64 exec, s[66:67]
    ds_write_b128 v19, v[52:55] offset:0
    ds_write_b128 v19, v[56:59] offset:256
    ds_write_b128 v19, v[60:63] offset:512
    s_mov_b64 exec, -1
    s_waitcnt vmcnt(15)
    v_mov_b32 v68, 0
    v_cmp_eq_u32 vcc, 0, v0
    s_nop 0
    s_mov_b64 exec, vcc
    ds_write_b32 v68, v23 offset:34304
    s_mov_b64 exec, -1
    s_waitcnt lgkmcnt(0)
    s_barrier
    ds_read2st64_b32 v[72:73], v20 offset0:0 offset1:3
    ds_read2st64_b32 v[74:75], v20 offset0:6 offset1:9
    ds_read2st64_b32 v[76:77], v20 offset0:12 offset1:15
    ds_read2st64_b32 v[78:79], v20 offset0:18 offset1:21
    ds_read_b32 v69, v68 offset:34304
    v_mov_b32 v22, 1
    s_add_u32 s53, s61, 0
    s_and_b32 s53, s53, 7
    s_mul_i32 s53, s53, 1280
    s_add_u32 s53, s53, s63
    s_cmp_ge_u32 s82, 8192
    s_cselect_b32 s53, 2146435072, s53
    buffer_atomic_add v22, v16, s[12:15], s53 offen sc0 sc1
    s_lshr_b32 s50, s49, 7
    s_mul_i32 s50, s50, 4
    s_bfe_u32 s51, s49, 131074
    s_add_u32 s50, s50, s51
    s_lshl_b32 s50, s50, 10
    s_add_u32 s50, s50, 6291456
    s_cmp_ge_u32 s49, 8192
    s_cselect_b32 s50, 2146435072, s50
    s_waitcnt lgkmcnt(0)
    v_readfirstlane_b32 s59, v69
    v_add_f32 v72, v72, v73
    v_add_f32 v74, v74, v75
    v_add_f32 v76, v76, v77
    v_add_f32 v78, v78, v79
    v_add_f32 v72, v72, v74
    v_add_f32 v76, v76, v78
    v_add_f32 v72, v72, v76
    v_cndmask_b32 v72, v72, 1.0, s[70:71]
    buffer_atomic_add_f32 v72, v21, s[12:15], s50 offen sc1
    s_min_u32 s50, s82, s83
    s_cmp_ge_u32 s50, 8192
    s_cbranch_scc1 L_exit_12
    s_mov_b32 s49, s83
    s_waitcnt vmcnt(30)
L_vchk_38:
    v_cmp_ne_u32 s[76:77], s57, v98
    v_cmp_ne_u32 s[78:79], s57, v102
    s_nop 0
    s_or_b64 s[76:77], s[76:77], s[78:79]
    s_nop 1
    s_cbranch_scc1 L_vslow_36
L_vback_37:
    v_mov_b32 v68, v96
    s_nop 1
    v_max_f32_dpp v68, v68, v68 quad_perm:[1,0,3,2] row_mask:0xf bank_mask:0xf
    s_nop 1
    v_max_f32_dpp v68, v68, v68 quad_perm:[2,3,0,1] row_mask:0xf bank_mask:0xf
    s_nop 1
    v_max_f32_dpp v68, v68, v68 row_half_mirror row_mask:0xf bank_mask:0xf
    s_nop 1
    v_max_f32_dpp v68, v68, v68 row_mirror row_mask:0xf bank_mask:0xf
    s_nop 1
    v_max_f32_dpp v68, v68, v68 row_bcast:15 row_mask:0xa bank_mask:0xf
    s_nop 0
    v_readlane_b32 s54, v68, 31
    s_nop 1
    v_subrev_f32 v69, s54, v96
    v_mul_f32 v69, 0x3fb8aa3b, v69
    v_exp_f32 v69, v69
    s_nop 0
    v_mul_f32 v69, v69, v97
    s_nop 1
    v_add_f32_dpp v69, v69, v69 quad_perm:[1,0,3,2] row_mask:0xf bank_mask:0xf
    s_nop 1
    v_add_f32_dpp v69, v69, v69 quad_perm:[2,3,0,1] row_mask:0xf bank_mask:0xf
    s_nop 1
    v_add_f32_dpp v69, v69, v69 row_half_mirror row_mask:0xf bank_mask:0xf
    s_nop 1
    v_add_f32_dpp v69, v69, v69 row_mirror row_mask:0xf bank_mask:0xf
    s_nop 1
    v_add_f32_dpp v69, v69, v69 row_bcast:15 row_mask:0xa bank_mask:0xf
    s_nop 0
    v_readlane_b32 s55, v69, 31
    s_nop 1
    v_rcp_f32 v70, s55
    v_lshlrev_b32 v72, 16, v100
    v_and_b32 v73, 0xffff0000, v100
    v_lshlrev_b32 v74, 16, v101
    v_and_b32 v75, 0xffff0000, v101
    v_subrev_f32 v72, s54, v72
    v_subrev_f32 v73, s54, v73
    v_subrev_f32 v74, s54, v74
    v_subrev_f32 v75, s54, v75
    v_mul_f32 v72, 0x3fb8aa3b, v72
    v_mul_f32 v73, 0x3fb8aa3b, v73
    v_mul_f32 v74, 0x3fb8aa3b, v74
    v_mul_f32 v75, 0x3fb8aa3b, v75
    v_exp_f32 v72, v72
    v_exp_f32 v73, v73
    v_exp_f32 v74, v74
    v_exp_f32 v75, v75
    v_mul_f32 v72, v72, v70
    v_mul_f32 v73, v73, v70
    v_mul_f32 v74, v74, v70
    v_mul_f32 v75, v75, v70
    v_cvt_pk_bf16_f32 v72, v72, v72
    v_cvt_pk_bf16_f32 v73, v73, v73
    v_cvt_pk_bf16_f32 v74, v74, v74
    v_cvt_pk_bf16_f32 v75, v75, v75
    v_and_b32 v28, v72, v9
    v_and_b32 v29, v72, v10
    v_and_b32 v30, v72, v11
    v_and_b32 v31, v72, v12
    v_and_b32 v32, v73, v9
    v_and_b32 v33, v73, v10
    v_and_b32 v34, v73, v11
    v_and_b32 v35, v73, v12
    v_and_b32 v36, v74, v9
    v_and_b32 v37, v74, v10
    v_and_b32 v38, v74, v11
    v_and_b32 v39, v74, v12
    v_and_b32 v40, v75, v9
    v_and_b32 v41, v75, v10
    v_and_b32 v42, v75, v11
    v_and_b32 v43, v75, v12
    s_waitcnt vmcnt(27)
    v_mfma_f32_16x16x32_bf16 v[52:55], a[48:51], v[28:31], 0
    v_mfma_f32_16x16x32_bf16 v[56:59], a[52:55], v[28:31], 0
    v_mfma_f32_16x16x32_bf16 v[60:63], a[56:59], v[28:31], 0
    s_waitcnt vmcnt(24)
    v_mfma_f32_16x16x32_bf16 v[52:55], a[60:63], v[32:35], v[52:55]
    v_mfma_f32_16x16x32_bf16 v[56:59], a[64:67], v[32:35], v[56:59]
    v_mfma_f32_16x16x32_bf16 v[60:63], a[68:71], v[32:35], v[60:63]
    s_waitcnt vmcnt(21)
    v_mfma_f32_16x16x32_bf16 v[52:55], a[72:75], v[36:39], v[52:55]
    v_mfma_f32_16x16x32_bf16 v[56:59], a[76:79], v[36:39], v[56:59]
    v_mfma_f32_16x16x32_bf16 v[60:63], a[80:83], v[36:39], v[60:63]
    s_waitcnt vmcnt(18)
    v_mfma_f32_16x16x32_bf16 v[52:55], a[84:87], v[40:43], v[52:55]
    v_mfma_f32_16x16x32_bf16 v[56:59], a[88:91], v[40:43], v[56:59]
    v_mfma_f32_16x16x32_bf16 v[60:63], a[92:95], v[40:43], v[60:63]
    s_add_u32 s50, s61, 1
    s_and_b32 s50, s50, 7
    s_mul_i32 s51, s59, 8
    s_add_u32 s51, s51, s50
    s_add_u32 s51, s51, 6144
    s_cmp_ge_u32 s83, 8192
    s_cselect_b32 s83, s83, s51
    s_cmp_ge_u32 s58, s56
    s_cselect_b32 s83, 0x100000, s83
    s_add_u32 s50, s58, 2
    s_cmp_ge_u32 s83, s86
    s_cselect_b32 s50, s50, s56
    s_cselect_b32 s63, 2146435072, s63
    s_min_u32 s56, s56, s50
    s_add_u32 s58, s58, 1
    s_min_u32 s50, s82, s83
    s_cmp_ge_u32 s50, 8192
    s_cbranch_scc1 L_nold_39
    s_lshr_b32 s51, s83, 7
    s_lshl_b32 s51, s51, 9
    s_add_u32 s51, s51, 786432
    s_lshl_b32 s52, s83, 9
    s_add_u32 s52, s52, 1048576
    s_cmp_lt_u32 s83, 8192
    s_cselect_b32 s51, s51, 2146435072
    s_cselect_b32 s52, s52, 2146435072
    s_mul_i32 s50, s83, 49152
    s_cselect_b32 s50, s50, 2146435072
    buffer_load_dwordx4 v[96:99], v24, s[12:15], s51 offen sc1
    buffer_load_dwordx4 v[100:103], v18, s[12:15], s52 offen sc1
    s_waitcnt vmcnt(11)
    buffer_load_dwordx4 a[48:51], v3, s[8:11], s50 offen offset:0 nt
    s_waitcnt vmcnt(11)
    buffer_load_dwordx4 a[52:55], v3, s[8:11], s50 offen offset:128 nt
    s_waitcnt vmcnt(11)
    buffer_load_dwordx4 a[56:59], v3, s[8:11], s50 offen offset:256 nt
    s_waitcnt vmcnt(11)
    buffer_load_dwordx4 a[60:63], v3, s[8:11], s50 offen offset:384 nt
    s_waitcnt vmcnt(11)
    buffer_load_dwordx4 a[64:67], v3, s[8:11], s50 offen offset:512 nt
    s_waitcnt vmcnt(11)
    buffer_load_dwordx4 a[68:71], v3, s[8:11], s50 offen offset:640 nt
    s_waitcnt vmcnt(11)
    buffer_load_dwordx4 a[72:75], v3, s[8:11], s50 offen offset:768 nt
    s_waitcnt vmcnt(11)
    buffer_load_dwordx4 a[76:79], v3, s[8:11], s50 offen offset:896 nt
    s_waitcnt vmcnt(7)
    buffer_load_dwordx4 a[80:83], v3, s[8:11], s50 offen offset:1024 nt
    s_waitcnt vmcnt(7)
    buffer_load_dwordx4 a[84:87], v3, s[8:11], s50 offen offset:1152 nt
    s_waitcnt vmcnt(7)
    buffer_load_dwordx4 a[88:91], v3, s[8:11], s50 offen offset:1280 nt
    s_waitcnt vmcnt(7)
    buffer_load_dwordx4 a[92:95], v3, s[8:11], s50 offen offset:1408 nt
L_nold_39:
    s_mov_b64 exec, s[66:67]
    ds_write_b128 v19, v[52:55] offset:6144
    ds_write_b128 v19, v[56:59] offset:6400
    ds_write_b128 v19, v[60:63] offset:6656
    s_mov_b64 exec, -1
    s_waitcnt vmcnt(15)
    v_mov_b32 v68, 0
    v_cmp_eq_u32 vcc, 0, v0
    s_nop 0
    s_mov_b64 exec, vcc
    ds_write_b32 v68, v22 offset:34308
    s_mov_b64 exec, -1
    s_waitcnt lgkmcnt(0)
    s_barrier
    ds_read2st64_b32 v[72:73], v20 offset0:24 offset1:27
    ds_read2st64_b32 v[74:75], v20 offset0:30 offset1:33
    ds_read2st64_b32 v[76:77], v20 offset0:36 offset1:39
    ds_read2st64_b32 v[78:79], v20 offset0:42 offset1:45
    ds_read_b32 v69, v68 offset:34308
    v_mov_b32 v23, 1
    s_add_u32 s53, s61, 1
    s_and_b32 s53, s53, 7
    s_mul_i32 s53, s53, 1280
    s_add_u32 s53, s53, s63
    s_cmp_ge_u32 s83, 8192
    s_cselect_b32 s53, 2146435072, s53
    buffer_atomic_add v23, v16, s[12:15], s53 offen sc0 sc1
    s_lshr_b32 s50, s49, 7
    s_mul_i32 s50, s50, 4
    s_bfe_u32 s51, s49, 131074
    s_add_u32 s50, s50, s51
    s_lshl_b32 s50, s50, 10
    s_add_u32 s50, s50, 6291456
    s_cmp_ge_u32 s49, 8192
    s_cselect_b32 s50, 2146435072, s50
    s_waitcnt lgkmcnt(0)
    v_readfirstlane_b32 s59, v69
    v_add_f32 v72, v72, v73
    v_add_f32 v74, v74, v75
    v_add_f32 v76, v76, v77
    v_add_f32 v78, v78, v79
    v_add_f32 v72, v72, v74
    v_add_f32 v76, v76, v78
    v_add_f32 v72, v72, v76
    v_cndmask_b32 v72, v72, 1.0, s[70:71]
    buffer_atomic_add_f32 v72, v21, s[12:15], s50 offen sc1
    s_branch L_vloop_31
L_exit_12:
    s_cmp_lt_u32 s2, 96
    s_cbranch_scc1 L_fin_40
    s_cmp_ge_u32 s2, 220
    s_cbranch_scc1 L_fin_40
    s_cmp_ge_u32 s2, 200
    s_cbranch_scc1 L_role3_42
    s_cmp_ge_u32 s2, 176
    s_cbranch_scc1 L_role2_41
    s_sub_u32 s51, s2, 96
    s_mul_i32 s50, s51, 6554
    s_lshr_b32 s50, s50, 16
    s_mul_i32 s52, s50, 10
    s_sub_u32 s51, s51, s52
    s_lshl_b32 s52, s50, 2
    s_add_u32 s52, s52, s48
    s_mul_i32 s90, s52, 4096
    s_add_u32 s90, s90, 6291456
    s_add_u32 s91, s90, 131072
    s_waitcnt vmcnt(40)
    buffer_load_dwordx4 v[120:123], v17, s[12:15], s90 offen offset:0 sc1
    buffer_load_dwordx4 v[124:127], v17, s[12:15], s90 offen offset:1024 sc1
    buffer_load_dwordx4 v[128:131], v17, s[12:15], s90 offen offset:2048 sc1
    buffer_load_dwordx4 v[132:135], v17, s[12:15], s90 offen offset:3072 sc1
    buffer_load_dwordx4 v[88:91], v17, s[12:15], s91 offen offset:0 sc1
    buffer_load_dwordx4 v[92:95], v17, s[12:15], s91 offen offset:1024 sc1
    buffer_load_dwordx4 v[96:99], v17, s[12:15], s91 offen offset:2048 sc1
    buffer_load_dwordx4 v[100:103], v17, s[12:15], s91 offen offset:3072 sc1
    s_mul_i32 s54, s50, 10240
    s_lshl_b32 s51, s51, 10
    s_add_u32 s54, s54, s51
    s_add_u32 s54, s54, 655360
    s_cmp_eq_u32 s48, 0
    s_cselect_b32 s54, s54, 2146435072
    s_mov_b32 s55, 2146435072
    s_mul_i32 s50, s48, 768
    v_mul_u32_u24 v70, 6, v1
    v_add_u32 v70, s50, v70
    v_and_b32 v71, 1, v1
    v_mul_u32_u24 v72, 384, v71
    v_lshrrev_b32 v73, 4, v1
    v_lshlrev_b32 v73, 4, v73
    v_add3_u32 v72, v72, v73, s50
    s_lshl_b32 s51, s48, 9
    s_add_u32 s51, s51, 50944
    v_lshl_add_u32 v73, v1, 2, s51
    v_bfe_u32 v74, v1, 1, 4
    v_lshl_add_u32 v74, v71, 5, v74
    v_lshrrev_b32 v75, 5, v1
    v_lshl_add_u32 v74, v75, 6, v74
    v_lshlrev_b32 v74, 2, v74
    v_add_u32 v74, 50944, v74
    v_add_u32 v69, 1024, v74
    v_mov_b32 v78, s57
    v_mov_b32 v79, 0
    s_mov_b32 s62, 0x42000000
    s_mov_b32 s93, 0x41b80000
    s_cmp_ge_u32 s2, 156
    s_cselect_b32 s87, 1, 0
    s_cmp_eq_u32 s87, 1
    s_cbranch_scc1 L_t1done_48
    s_branch L_t1top0_43
L_t1p0_44:
    buffer_load_dwordx4 v[120:123], v17, s[12:15], s90 offen offset:0 sc1
    buffer_load_dwordx4 v[124:127], v17, s[12:15], s90 offen offset:1024 sc1
    buffer_load_dwordx4 v[128:131], v17, s[12:15], s90 offen offset:2048 sc1
    buffer_load_dwordx4 v[132:135], v17, s[12:15], s90 offen offset:3072 sc1
L_t1top0_43:
    s_mov_b32 s55, s54
    s_waitcnt vmcnt(0)
    v_min3_f32 v75, v123, v127, v131
    v_min_f32 v75, v75, v135
    v_cmp_neq_f32 s[76:77], s62, v75
    v_pk_add_f32 v[120:121], v[120:121], v[124:125]
    v_add_f32 v122, v122, v126
    v_pk_add_f32 v[128:129], v[128:129], v[132:133]
    v_add_f32 v130, v130, v134
    v_pk_add_f32 v[120:121], v[120:121], v[128:129]
    v_add_f32 v122, v122, v130
    s_cmp_eq_u64 s[76:77], 0
    s_cbranch_scc1 L_t1d0_45
    s_add_u32 s60, s60, 1
    s_cmp_lt_u32 s60, 131072
    s_sleep 8
    s_cbranch_scc1 L_t1p0_44
    v_mov_b32 v68, 72
    buffer_atomic_add v26, v68, s[40:43], 0 offen sc1
L_t1d0_45:
    v_cvt_pk_bf16_f32 v80, v120, v121
    v_cvt_pk_bf16_f32 v81, v122, v122
    ds_write_b16 v70, v80 offset:46848
    ds_write_b16_d16_hi v70, v80 offset:46850
    ds_write_b16 v70, v81 offset:46852
    s_branch L_t1top_46
L_t1poll_47:
    buffer_load_dwordx4 v[88:91], v17, s[12:15], s91 offen offset:0 sc1
    buffer_load_dwordx4 v[92:95], v17, s[12:15], s91 offen offset:1024 sc1
    buffer_load_dwordx4 v[96:99], v17, s[12:15], s91 offen offset:2048 sc1
    buffer_load_dwordx4 v[100:103], v17, s[12:15], s91 offen offset:3072 sc1
    s_waitcnt vmcnt(0)
L_t1top_46:
    v_min3_f32 v75, v91, v95, v99
    v_min_f32 v75, v75, v103
    v_cmp_neq_f32 s[76:77], s62, v75
    v_pk_add_f32 v[88:89], v[88:89], v[92:93]
    v_add_f32 v90, v90, v94
    v_pk_add_f32 v[96:97], v[96:97], v[100:101]
    v_add_f32 v98, v98, v102
    v_pk_add_f32 v[88:89], v[88:89], v[96:97]
    v_add_f32 v90, v90, v98
    s_cmp_eq_u64 s[76:77], 0
    s_cbranch_scc1 L_t1done_48
    v_cmp_gt_f32 s[76:77], s93, v75
    s_nop 0
    s_cmp_eq_u64 s[76:77], 0
    s_nop 1
    s_cbranch_scc1 L_t1q_50
    s_sleep 24
L_t1q_50:
    s_add_u32 s60, s60, 1
    s_cmp_lt_u32 s60, 131072
    s_cbranch_scc1 L_t1poll_47
    v_mov_b32 v68, 72
    buffer_atomic_add v26, v68, s[40:43], 0 offen sc1
L_t1done_48:
    v_cvt_pk_bf16_f32 v80, v88, v89
    v_cvt_pk_bf16_f32 v81, v90, v90
    ds_write_b16 v70, v80 offset:47232
    ds_write_b16_d16_hi v70, v80 offset:47234
    ds_write_b16 v70, v81 offset:47236
    ds_read_b128 v[28:31], v72 offset:46848
    ds_read_b128 v[32:35], v72 offset:46912
    ds_read_b128 v[36:39], v72 offset:46976
    ds_read_b128 v[40:43], v72 offset:47040
    ds_read_b128 v[44:47], v72 offset:47104
    ds_read_b128 v[48:51], v72 offset:47168
    s_waitcnt lgkmcnt(5)
    v_mfma_f32_16x16x32_bf16 v[52:55], v[28:31], v[160:163], 0
    v_mfma_f32_16x16x32_bf16 v[56:59], v[28:31], v[164:167], 0
    v_mfma_f32_16x16x32_bf16 v[60:63], v[28:31], v[168:171], 0
    v_mfma_f32_16x16x32_bf16 v[64:67], v[28:31], v[172:175], 0
    s_waitcnt lgkmcnt(4)
    v_mfma_f32_16x16x32_bf16 v[52:55], v[32:35], v[176:179], v[52:55]
    v_mfma_f32_16x16x32_bf16 v[56:59], v[32:35], v[180:183], v[56:59]
    v_mfma_f32_16x16x32_bf16 v[60:63], v[32:35], v[184:187], v[60:63]
    v_mfma_f32_16x16x32_bf16 v[64:67], v[32:35], v[188:191], v[64:67]
    s_waitcnt lgkmcnt(3)
    v_mfma_f32_16x16x32_bf16 v[52:55], v[36:39], v[192:195], v[52:55]
    v_mfma_f32_16x16x32_bf16 v[56:59], v[36:39], v[196:199], v[56:59]
    v_mfma_f32_16x16x32_bf16 v[60:63], v[36:39], v[200:203], v[60:63]
    v_mfma_f32_16x16x32_bf16 v[64:67], v[36:39], v[204:207], v[64:67]
    s_waitcnt lgkmcnt(2)
    v_mfma_f32_16x16x32_bf16 v[52:55], v[40:43], v[208:211], v[52:55]
    v_mfma_f32_16x16x32_bf16 v[56:59], v[40:43], v[212:215], v[56:59]
    v_mfma_f32_16x16x32_bf16 v[60:63], v[40:43], v[216:219], v[60:63]
    v_mfma_f32_16x16x32_bf16 v[64:67], v[40:43], v[220:223], v[64:67]
    s_waitcnt lgkmcnt(1)
    v_mfma_f32_16x16x32_bf16 v[52:55], v[44:47], v[224:227], v[52:55]
    v_mfma_f32_16x16x32_bf16 v[56:59], v[44:47], v[228:231], v[56:59]
    v_mfma_f32_16x16x32_bf16 v[60:63], v[44:47], v[232:235], v[60:63]
    v_mfma_f32_16x16x32_bf16 v[64:67], v[44:47], v[236:239], v[64:67]
    s_waitcnt lgkmcnt(0)
    v_mfma_f32_16x16x32_bf16 v[52:55], v[48:51], v[240:243], v[52:55]
    v_mfma_f32_16x16x32_bf16 v[56:59], v[48:51], v[244:247], v[56:59]
    v_mfma_f32_16x16x32_bf16 v[60:63], v[48:51], v[248:251], v[60:63]
    v_mfma_f32_16x16x32_bf16 v[64:67], v[48:51], v[252:255], v[64:67]
    s_mov_b64 exec, 0xffff
    s_nop 3
    ds_write2_b32 v73, v52, v53 offset0:0 offset1:16
    ds_write2_b32 v73, v56, v57 offset0:32 offset1:48
    ds_write2_b32 v73, v60, v61 offset0:64 offset1:80
    ds_write2_b32 v73, v64, v65 offset0:96 offset1:112
    s_mov_b64 exec, -1
    s_waitcnt lgkmcnt(0)
    s_barrier
    ds_read2_b32 v[52:53], v74 offset0:0 offset1:16
    ds_read2_b32 v[54:55], v74 offset0:128 offset1:144
    ds_read2_b32 v[56:57], v69 offset0:0 offset1:16
    ds_read2_b32 v[58:59], v69 offset0:128 offset1:144
    s_waitcnt lgkmcnt(0)
    v_add_f32 v52, v52, v54
    v_add_f32 v56, v56, v58
    v_add_f32 v53, v53, v55
    v_add_f32 v57, v57, v59
    v_add_f32 v76, v52, v56
    v_add_f32 v77, v53, v57
    buffer_store_dwordx4 v[76:79], v17, s[12:15], s55 offen sc1
    s_cmp_eq_u32 s87, 0
    s_cbranch_scc1 L_t1fin_49
    s_mov_b32 s87, 0
    s_barrier
    s_branch L_t1top0_43
L_t1fin_49:
    s_branch L_fin_40
L_role2_41:
    s_waitcnt vmcnt(30)
    s_mov_b32 s44, s16
    s_mov_b32 s45, s17
    s_mov_b32 s46, 2560
    s_mov_b32 s47, 0x20000
    s_mul_i32 s50, s48, 320
    v_lshl_add_u32 v68, v1, 1, s50
    v_mov_b32 v69, 2146435072
    v_cndmask_b32 v69, v69, v68, s[74:75]
    buffer_load_ushort v88, v68, s[44:47], 0 offen offset:0
    buffer_load_ushort v89, v68, s[44:47], 0 offen offset:128
    buffer_load_ushort v90, v69, s[44:47], 0 offen offset:256
    buffer_load_ushort v91, v68, s[44:47], 0 offen offset:1280
    buffer_load_ushort v92, v68, s[44:47], 0 offen offset:1408
    buffer_load_ushort v93, v69, s[44:47], 0 offen offset:1536
    s_lshl_b32 s50, s48, 4
    v_mov_b32 v86, s50
    v_and_b32 v87, 1, v1
    v_lshlrev_b32 v87, 3, v87
    s_sub_u32 s90, s2, 176
    s_mul_i32 s91, s48, 2560
    s_add_u32 s91, s91, 655360
    v_and_b32 v152, 31, v1
    v_lshlrev_b32 v152, 4, v152
    s_mul_i32 s50, s48, 640
    v_lshl_add_u32 v153, v1, 1, s50
    v_and_b32 v154, 1, v1
    v_mul_u32_u24 v154, 320, v154
    v_lshrrev_b32 v155, 4, v1
    v_lshlrev_b32 v155, 4, v155
    v_add3_u32 v154, v154, v155, s50
    s_lshl_b32 s50, s48, 10
    s_add_u32 s50, s50, 50944
    v_lshl_add_u32 v155, v1, 2, s50
    v_and_b32 v156, 1, v1
    v_lshrrev_b32 v157, 1, v1
    v_lshl_add_u32 v156, v156, 5, v157
    s_and_b32 s51, s48, 1
    s_lshl_b32 s50, s51, 8
    s_add_u32 s50, s50, 50944
    v_lshl_add_u32 v156, v156, 2, s50
    v_lshrrev_b32 v158, 5, v1
    v_mul_u32_u24 v158, 3072, v158
    v_and_b32 v157, 15, v157
    v_lshl_add_u32 v157, v157, 2, v158
    v_mov_b32 v158, 2146435072
    v_and_b32 v159, 7, v1
    v_cmp_eq_u32 vcc, 0, v159
    s_nop 1
    v_cndmask_b32 v157, v158, v157, vcc
    v_mov_b32 v158, 0x7fff7fff
    s_lshl_b32 s62, s90, 1
    s_add_u32 s62, s62, s48
    s_lshl_b32 s62, s62, 6
    s_add_u32 s62, s62, 6279168
    s_cmp_lt_u32 s48, 2
    s_cselect_b32 s62, s62, 2146435072
    s_mov_b32 s87, 1
    s_mov_b32 s55, 2146435072
    s_waitcnt vmcnt(0)
    v_lshlrev_b32 v88, 16, v88
    v_lshlrev_b32 v89, 16, v89
    v_lshlrev_b32 v90, 16, v90
    v_lshlrev_b32 v91, 16, v91
    v_lshlrev_b32 v92, 16, v92
    v_lshlrev_b32 v93, 16, v93
    s_nop 0
    s_branch L_t2done_52
L_t2pre_53:
L_t2poll_51:
    s_add_u32 s92, s91, 0
    buffer_load_dwordx4 v[104:107], v17, s[12:15], s92 offen offset:0 sc1
    buffer_load_dwordx4 v[108:111], v17, s[12:15], s92 offen offset:1024 sc1
    buffer_load_dwordx4 v[112:115], v152, s[12:15], s92 offen offset:2048 sc1
    s_add_u32 s92, s92, 10240
    buffer_load_dwordx4 v[116:119], v17, s[12:15], s92 offen offset:0 sc1
    buffer_load_dwordx4 v[120:123], v17, s[12:15], s92 offen offset:1024 sc1
    buffer_load_dwordx4 v[124:127], v152, s[12:15], s92 offen offset:2048 sc1
    s_add_u32 s92, s92, 10240
    buffer_load_dwordx4 v[128:131], v17, s[12:15], s92 offen offset:0 sc1
    buffer_load_dwordx4 v[132:135], v17, s[12:15], s92 offen offset:1024 sc1
    buffer_load_dwordx4 v[136:139], v152, s[12:15], s92 offen offset:2048 sc1
    s_add_u32 s92, s92, 10240
    buffer_load_dwordx4 v[140:143], v17, s[12:15], s92 offen offset:0 sc1
    buffer_load_dwordx4 v[144:147], v17, s[12:15], s92 offen offset:1024 sc1
    buffer_load_dwordx4 v[148:151], v152, s[12:15], s92 offen offset:2048 sc1
    s_add_u32 s92, s92, 10240
    buffer_load_dwordx4 v[28:31], v17, s[12:15], s92 offen offset:0 sc1
    buffer_load_dwordx4 v[32:35], v17, s[12:15], s92 offen offset:1024 sc1
    buffer_load_dwordx4 v[36:39], v152, s[12:15], s92 offen offset:2048 sc1
    s_add_u32 s92, s92, 10240
    buffer_load_dwordx4 v[40:43], v17, s[12:15], s92 offen offset:0 sc1
    buffer_load_dwordx4 v[44:47], v17, s[12:15], s92 offen offset:1024 sc1
    buffer_load_dwordx4 v[48:51], v152, s[12:15], s92 offen offset:2048 sc1
    s_add_u32 s92, s92, 10240
    buffer_load_dwordx4 v[52:55], v17, s[12:15], s92 offen offset:0 sc1
    buffer_load_dwordx4 v[56:59], v17, s[12:15], s92 offen offset:1024 sc1
    buffer_load_dwordx4 v[60:63], v152, s[12:15], s92 offen offset:2048 sc1
    s_add_u32 s92, s92, 10240
    buffer_load_dwordx4 v[64:67], v17, s[12:15], s92 offen offset:0 sc1
    buffer_load_dwordx4 v[100:103], v17, s[12:15], s92 offen offset:1024 sc1
    buffer_load_dwordx4 v[80:83], v152, s[12:15], s92 offen offset:2048 sc1
    s_waitcnt vmcnt(18)
    v_bitop3_b32 v69, v106, v118, s57 bitop3:0x7e
    v_pk_add_f32 v[104:105], v[116:117], v[104:105]
    v_bitop3_b32 v70, v110, v122, s57 bitop3:0x7e
    v_pk_add_f32 v[108:109], v[120:121], v[108:109]
    v_bitop3_b32 v71, v114, v126, s57 bitop3:0x7e
    v_pk_add_f32 v[112:113], v[124:125], v[112:113]
    v_or3_b32 v72, v69, v70, v71
    s_waitcnt vmcnt(12)
    v_bitop3_b32 v69, v130, v142, s57 bitop3:0x7e
    v_pk_add_f32 v[128:129], v[140:141], v[128:129]
    v_bitop3_b32 v70, v134, v146, s57 bitop3:0x7e
    v_pk_add_f32 v[132:133], v[144:145], v[132:133]
    v_bitop3_b32 v71, v138, v150, s57 bitop3:0x7e
    v_pk_add_f32 v[136:137], v[148:149], v[136:137]
    v_or3_b32 v73, v69, v70, v71
    v_pk_add_f32 v[104:105], v[104:105], v[128:129]
    v_pk_add_f32 v[108:109], v[108:109], v[132:133]
    v_pk_add_f32 v[112:113], v[112:113], v[136:137]
    s_waitcnt vmcnt(6)
    v_bitop3_b32 v69, v30, v42, s57 bitop3:0x7e
    v_pk_add_f32 v[28:29], v[40:41], v[28:29]
    v_bitop3_b32 v70, v34, v46, s57 bitop3:0x7e
    v_pk_add_f32 v[32:33], v[44:45], v[32:33]
    v_bitop3_b32 v71, v38, v50, s57 bitop3:0x7e
    v_pk_add_f32 v[36:37], v[48:49], v[36:37]
    v_or3_b32 v74, v69, v70, v71
    v_pk_add_f32 v[104:105], v[104:105], v[28:29]
    v_pk_add_f32 v[108:109], v[108:109], v[32:33]
    v_pk_add_f32 v[112:113], v[112:113], v[36:37]
    v_or3_b32 v72, v72, v73, v74
    v_cmp_ne_u32 s[76:77], 0, v72
    s_nop 0
    s_cmp_lg_u64 s[76:77], 0
    s_nop 1
    s_cbranch_scc0 L_t2cb_55
    s_waitcnt vmcnt(0)
    s_add_u32 s60, s60, 1
    s_cmp_lt_u32 s60, 131072
    s_sleep 1
    s_cbranch_scc1 L_t2poll_51
    v_mov_b32 v68, 76
    buffer_atomic_add v26, v68, s[40:43], 0 offen sc1
    s_branch L_t2cb_55
L_t2pb_54:
    s_add_u32 s92, s91, 61440
    buffer_load_dwordx4 v[52:55], v17, s[12:15], s92 offen offset:0 sc1
    buffer_load_dwordx4 v[56:59], v17, s[12:15], s92 offen offset:1024 sc1
    buffer_load_dwordx4 v[60:63], v152, s[12:15], s92 offen offset:2048 sc1
    s_add_u32 s92, s92, 10240
    buffer_load_dwordx4 v[64:67], v17, s[12:15], s92 offen offset:0 sc1
    buffer_load_dwordx4 v[100:103], v17, s[12:15], s92 offen offset:1024 sc1
    buffer_load_dwordx4 v[80:83], v152, s[12:15], s92 offen offset:2048 sc1
L_t2cb_55:
    s_waitcnt vmcnt(0)
    v_bitop3_b32 v69, v54, v66, s57 bitop3:0x7e
    v_pk_add_f32 v[52:53], v[64:65], v[52:53]
    v_bitop3_b32 v70, v58, v102, s57 bitop3:0x7e
    v_pk_add_f32 v[56:57], v[100:101], v[56:57]
    v_bitop3_b32 v71, v62, v82, s57 bitop3:0x7e
    v_pk_add_f32 v[60:61], v[80:81], v[60:61]
    v_or3_b32 v72, v69, v70, v71
    v_cmp_ne_u32 s[76:77], 0, v72
    v_pk_add_f32 v[76:77], v[104:105], v[52:53]
    v_pk_add_f32 v[78:79], v[108:109], v[56:57]
    v_pk_add_f32 v[80:81], v[112:113], v[60:61]
    s_cmp_lg_u64 s[76:77], 0
    s_cbranch_scc0 L_t2done_52
    s_add_u32 s60, s60, 1
    s_cmp_lt_u32 s60, 131072
    s_cbranch_scc1 L_t2pb_54
    v_mov_b32 v68, 76
    buffer_atomic_add v26, v68, s[40:43], 0 offen sc1
L_t2done_52:
    v_cvt_pk_bf16_f32 v68, v76, v77
    v_cvt_pk_bf16_f32 v69, v78, v79
    v_cvt_pk_bf16_f32 v70, v80, v81
    v_lshlrev_b32 v94, 16, v68
    v_and_b32 v97, 0xffff0000, v68
    v_lshlrev_b32 v95, 16, v69
    v_and_b32 v98, 0xffff0000, v69
    v_lshlrev_b32 v96, 16, v70
    v_and_b32 v99, 0xffff0000, v70
    v_add_f32 v94, v94, v88
    v_add_f32 v97, v97, v91
    v_add_f32 v95, v95, v89
    v_add_f32 v98, v98, v92
    v_add_f32 v96, v96, v90
    v_add_f32 v99, v99, v93
    v_cvt_pk_bf16_f32 v68, v94, v97
    v_cvt_pk_bf16_f32 v69, v95, v98
    v_cvt_pk_bf16_f32 v70, v96, v99
    v_lshlrev_b32 v94, 16, v68
    v_and_b32 v97, 0xffff0000, v68
    v_lshlrev_b32 v95, 16, v69
    v_and_b32 v98, 0xffff0000, v69
    v_lshlrev_b32 v96, 16, v70
    v_and_b32 v99, 0xffff0000, v70
    v_readlane_b32 s50, v94, 0
    v_readlane_b32 s51, v97, 0
    s_nop 0
    v_subrev_f32 v76, s50, v94
    v_subrev_f32 v79, s51, v97
    v_subrev_f32 v77, s50, v95
    v_subrev_f32 v80, s51, v98
    v_subrev_f32 v78, s50, v96
    v_subrev_f32 v81, s51, v99
    v_cndmask_b32 v78, 0, v78, s[74:75]
    v_cndmask_b32 v81, 0, v81, s[74:75]
    v_add_f32 v68, v76, v77
    v_mul_f32 v69, v76, v76
    v_add_f32 v70, v79, v80
    v_mul_f32 v71, v79, v79
    v_add_f32 v68, v68, v78
    v_fmac_f32 v69, v77, v77
    v_add_f32 v70, v70, v81
    v_fmac_f32 v71, v80, v80
    v_fmac_f32 v69, v78, v78
    v_fmac_f32 v71, v81, v81
    v_add_f32_dpp v68, v68, v68 quad_perm:[1,0,3,2] row_mask:0xf bank_mask:0xf
    v_add_f32_dpp v70, v70, v70 quad_perm:[1,0,3,2] row_mask:0xf bank_mask:0xf
    v_add_f32_dpp v69, v69, v69 quad_perm:[1,0,3,2] row_mask:0xf bank_mask:0xf
    v_add_f32_dpp v71, v71, v71 quad_perm:[1,0,3,2] row_mask:0xf bank_mask:0xf
    v_add_f32_dpp v68, v68, v68 quad_perm:[2,3,0,1] row_mask:0xf bank_mask:0xf
    v_add_f32_dpp v70, v70, v70 quad_perm:[2,3,0,1] row_mask:0xf bank_mask:0xf
    v_add_f32_dpp v69, v69, v69 quad_perm:[2,3,0,1] row_mask:0xf bank_mask:0xf
    v_add_f32_dpp v71, v71, v71 quad_perm:[2,3,0,1] row_mask:0xf bank_mask:0xf
    v_add_f32_dpp v68, v68, v68 row_half_mirror row_mask:0xf bank_mask:0xf
    v_add_f32_dpp v70, v70, v70 row_half_mirror row_mask:0xf bank_mask:0xf
    v_add_f32_dpp v69, v69, v69 row_half_mirror row_mask:0xf bank_mask:0xf
    v_add_f32_dpp v71, v71, v71 row_half_mirror row_mask:0xf bank_mask:0xf
    v_add_f32_dpp v68, v68, v68 row_mirror row_mask:0xf bank_mask:0xf
    v_add_f32_dpp v70, v70, v70 row_mirror row_mask:0xf bank_mask:0xf
    v_add_f32_dpp v69, v69, v69 row_mirror row_mask:0xf bank_mask:0xf
    v_add_f32_dpp v71, v71, v71 row_mirror row_mask:0xf bank_mask:0xf
    v_add_f32_dpp v68, v68, v68 row_bcast:15 row_mask:0xa bank_mask:0xf
    v_add_f32_dpp v70, v70, v70 row_bcast:15 row_mask:0xa bank_mask:0xf
    v_add_f32_dpp v69, v69, v69 row_bcast:15 row_mask:0xa bank_mask:0xf
    v_add_f32_dpp v71, v71, v71 row_bcast:15 row_mask:0xa bank_mask:0xf
    v_add_f32_dpp v68, v68, v68 row_bcast:31 row_mask:0xc bank_mask:0xf
    v_add_f32_dpp v70, v70, v70 row_bcast:31 row_mask:0xc bank_mask:0xf
    v_add_f32_dpp v69, v69, v69 row_bcast:31 row_mask:0xc bank_mask:0xf
    v_add_f32_dpp v71, v71, v71 row_bcast:31 row_mask:0xc bank_mask:0xf
    v_mul_f32 v72, 0x3bcccccd, v68
    v_mul_f32 v73, 0x3bcccccd, v70
    v_fma_f32 v69, -v72, v68, v69
    v_add_f32 v68, s50, v72
    v_fma_f32 v71, -v73, v70, v71
    v_add_f32 v70, s51, v73
    s_mov_b64 exec, s[68:69]
    ds_write_b128 v86, v[68:71] offset:46848
    s_mov_b64 exec, -1
    s_waitcnt lgkmcnt(0)
    s_barrier
    ds_read_b64 v[52:53], v87 offset:46848
    ds_read_b64 v[54:55], v87 offset:46864
    ds_read_b64 v[56:57], v87 offset:46880
    ds_read_b64 v[58:59], v87 offset:46896
    s_waitcnt lgkmcnt(0)
    v_add_f32 v72, v52, v54
    v_add_f32 v74, v56, v58
    v_add_f32 v73, v53, v55
    v_add_f32 v72, v72, v74
    v_add_f32 v74, v57, v59
    v_mul_f32 v72, 0x3e800000, v72
    v_add_f32 v73, v73, v74
    v_sub_f32 v52, v52, v72
    v_sub_f32 v54, v54, v72
    v_sub_f32 v56, v56, v72
    v_sub_f32 v58, v58, v72
    v_mul_f32 v73, 0x3acccccd, v73
    v_mul_f32 v74, v52, v52
    v_fmac_f32 v74, v54, v54
    v_fmac_f32 v74, v56, v56
    v_fmac_f32 v74, v58, v58
    v_cvt_pk_bf16_f32 v72, v72, v72
    v_fmac_f32 v73, 0x3e800000, v74
    v_and_b32 v72, 0xffff0000, v72
    v_max_f32 v73, 0, v73
    v_cvt_pk_bf16_f32 v73, v73, v73
    v_and_b32 v73, 0xffff0000, v73
    v_readlane_b32 s50, v72, 0
    v_readlane_b32 s51, v72, 1
    v_add_f32 v73, 0x3727c5ac, v73
    v_cvt_pk_bf16_f32 v73, v73, v73
    v_and_b32 v73, 0xffff0000, v73
    v_sqrt_f32 v73, v73
    v_subrev_f32 v94, s50, v94
    v_subrev_f32 v95, s50, v95
    v_subrev_f32 v96, s50, v96
    v_subrev_f32 v97, s51, v97
    v_subrev_f32 v98, s51, v98
    v_subrev_f32 v99, s51, v99
    v_cvt_pk_bf16_f32 v73, v73, v73
    v_and_b32 v73, 0xffff0000, v73
    v_rcp_f32 v73, v73
    v_cvt_pk_bf16_f32 v94, v94, v94
    v_cvt_pk_bf16_f32 v95, v95, v95
    v_cvt_pk_bf16_f32 v96, v96, v96
    v_cvt_pk_bf16_f32 v97, v97, v97
    v_cvt_pk_bf16_f32 v98, v98, v98
    v_cvt_pk_bf16_f32 v99, v99, v99
    v_readlane_b32 s52, v73, 0
    v_readlane_b32 s53, v73, 1
    v_and_b32 v94, 0xffff0000, v94
    v_and_b32 v95, 0xffff0000, v95
    v_and_b32 v96, 0xffff0000, v96
    v_and_b32 v97, 0xffff0000, v97
    v_and_b32 v98, 0xffff0000, v98
    v_and_b32 v99, 0xffff0000, v99
    v_mul_f32 v94, s52, v94
    v_mul_f32 v95, s52, v95
    v_mul_f32 v96, s52, v96
    v_mul_f32 v97, s53, v97
    v_mul_f32 v98, s53, v98
    v_mul_f32 v99, s53, v99
    v_cvt_pk_bf16_f32 v94, v94, v94
    v_cvt_pk_bf16_f32 v95, v95, v95
    v_cvt_pk_bf16_f32 v96, v96, v96
    v_cvt_pk_bf16_f32 v97, v97, v97
    v_cvt_pk_bf16_f32 v98, v98, v98
    v_cvt_pk_bf16_f32 v99, v99, v99
    ds_write_b16 v153, v94 offset:46912
    ds_write_b16 v153, v95 offset:47040
    ds_write_b16 v153, v97 offset:47232
    ds_write_b16 v153, v98 offset:47360
    s_mov_b64 exec, s[74:75]
    ds_write_b16 v153, v96 offset:47168
    ds_write_b16 v153, v99 offset:47488
    s_mov_b64 exec, -1
    ds_read_b128 v[28:31], v154 offset:46912
    ds_read_b128 v[32:35], v154 offset:46976
    ds_read_b128 v[36:39], v154 offset:47040
    ds_read_b128 v[40:43], v154 offset:47104
    ds_read_b128 v[44:47], v154 offset:47168
    s_waitcnt lgkmcnt(4)
    v_mfma_f32_16x16x32_bf16 v[104:107], v[28:31], v[160:163], 0
    v_mfma_f32_16x16x32_bf16 v[108:111], v[28:31], v[164:167], 0
    v_mfma_f32_16x16x32_bf16 v[112:115], v[28:31], v[168:171], 0
    v_mfma_f32_16x16x32_bf16 v[116:119], v[28:31], v[172:175], 0
    v_mfma_f32_16x16x32_bf16 v[120:123], v[28:31], v[240:243], 0
    v_mfma_f32_16x16x32_bf16 v[124:127], v[28:31], v[244:247], 0
    v_mfma_f32_16x16x32_bf16 v[128:131], v[28:31], v[248:251], 0
    v_mfma_f32_16x16x32_bf16 v[132:135], v[28:31], v[252:255], 0
    s_waitcnt lgkmcnt(3)
    v_mfma_f32_16x16x32_bf16 v[104:107], v[32:35], v[176:179], v[104:107]
    v_mfma_f32_16x16x32_bf16 v[108:111], v[32:35], v[180:183], v[108:111]
    v_mfma_f32_16x16x32_bf16 v[112:115], v[32:35], v[184:187], v[112:115]
    v_mfma_f32_16x16x32_bf16 v[116:119], v[32:35], v[188:191], v[116:119]
    v_mfma_f32_16x16x32_bf16 v[120:123], v[32:35], a[192:195], v[120:123]
    v_mfma_f32_16x16x32_bf16 v[124:127], v[32:35], a[196:199], v[124:127]
    v_mfma_f32_16x16x32_bf16 v[128:131], v[32:35], a[200:203], v[128:131]
    v_mfma_f32_16x16x32_bf16 v[132:135], v[32:35], a[204:207], v[132:135]
    s_waitcnt lgkmcnt(2)
    v_mfma_f32_16x16x32_bf16 v[104:107], v[36:39], v[192:195], v[104:107]
    v_mfma_f32_16x16x32_bf16 v[108:111], v[36:39], v[196:199], v[108:111]
    v_mfma_f32_16x16x32_bf16 v[112:115], v[36:39], v[200:203], v[112:115]
    v_mfma_f32_16x16x32_bf16 v[116:119], v[36:39], v[204:207], v[116:119]
    v_mfma_f32_16x16x32_bf16 v[120:123], v[36:39], a[208:211], v[120:123]
    v_mfma_f32_16x16x32_bf16 v[124:127], v[36:39], a[212:215], v[124:127]
    v_mfma_f32_16x16x32_bf16 v[128:131], v[36:39], a[216:219], v[128:131]
    v_mfma_f32_16x16x32_bf16 v[132:135], v[36:39], a[220:223], v[132:135]
    s_waitcnt lgkmcnt(1)
    v_mfma_f32_16x16x32_bf16 v[104:107], v[40:43], v[208:211], v[104:107]
    v_mfma_f32_16x16x32_bf16 v[108:111], v[40:43], v[212:215], v[108:111]
    v_mfma_f32_16x16x32_bf16 v[112:115], v[40:43], v[216:219], v[112:115]
    v_mfma_f32_16x16x32_bf16 v[116:119], v[40:43], v[220:223], v[116:119]
    v_mfma_f32_16x16x32_bf16 v[120:123], v[40:43], a[224:227], v[120:123]
    v_mfma_f32_16x16x32_bf16 v[124:127], v[40:43], a[228:231], v[124:127]
    v_mfma_f32_16x16x32_bf16 v[128:131], v[40:43], a[232:235], v[128:131]
    v_mfma_f32_16x16x32_bf16 v[132:135], v[40:43], a[236:239], v[132:135]
    s_waitcnt lgkmcnt(0)
    v_mfma_f32_16x16x32_bf16 v[104:107], v[44:47], v[224:227], v[104:107]
    v_mfma_f32_16x16x32_bf16 v[108:111], v[44:47], v[228:231], v[108:111]
    v_mfma_f32_16x16x32_bf16 v[112:115], v[44:47], v[232:235], v[112:115]
    v_mfma_f32_16x16x32_bf16 v[116:119], v[44:47], v[236:239], v[116:119]
    v_mfma_f32_16x16x32_bf16 v[120:123], v[44:47], a[240:243], v[120:123]
    v_mfma_f32_16x16x32_bf16 v[124:127], v[44:47], a[244:247], v[124:127]
    v_mfma_f32_16x16x32_bf16 v[128:131], v[44:47], a[248:251], v[128:131]
    v_mfma_f32_16x16x32_bf16 v[132:135], v[44:47], a[252:255], v[132:135]
    s_mov_b64 exec, 0xffff
    ds_write2_b32 v155, v104, v105 offset0:0 offset1:16
    ds_write2_b32 v155, v108, v109 offset0:32 offset1:48
    ds_write2_b32 v155, v112, v113 offset0:64 offset1:80
    ds_write2_b32 v155, v116, v117 offset0:96 offset1:112
    ds_write2_b32 v155, v120, v121 offset0:128 offset1:144
    ds_write2_b32 v155, v124, v125 offset0:160 offset1:176
    ds_write2_b32 v155, v128, v129 offset0:192 offset1:208
    ds_write2_b32 v155, v132, v133 offset0:224 offset1:240
    s_mov_b64 exec, -1
    s_waitcnt lgkmcnt(0)
    s_barrier
    ds_read2st64_b32 v[52:53], v156 offset0:0 offset1:2
    ds_read2st64_b32 v[54:55], v156 offset0:4 offset1:6
    ds_read2st64_b32 v[56:57], v156 offset0:8 offset1:10
    ds_read2st64_b32 v[58:59], v156 offset0:12 offset1:14
    s_waitcnt lgkmcnt(0)
    v_add_f32 v52, v52, v54
    v_add_f32 v56, v56, v58
    v_add_f32 v53, v53, v55
    v_add_f32 v57, v57, v59
    v_add_f32 v52, v52, v56
    v_add_f32 v53, v53, v57
    v_cvt_pk_bf16_f32 v52, v52, v53
    v_and_b32 v53, 0xffff0000, v52
    v_lshlrev_b32 v52, 16, v52
    v_mul_f32 v54, v52, v52
    v_mul_f32 v54, 0xbdd2d3e8, v54
    v_add_f32 v54, 0xc0135761, v54
    v_mul_f32 v54, v54, v52
    v_exp_f32 v54, v54
    s_nop 0
    v_add_f32 v54, 1.0, v54
    v_rcp_f32 v54, v54
    s_nop 0
    v_mul_f32 v52, v52, v54
    v_cvt_pk_bf16_f32 v52, v52, v52
    v_and_b32 v52, 0xffff0000, v52
    v_mul_f32 v52, v52, v53
    s_nop 1
    v_mov_b32_dpp v54, v52 quad_perm:[1,1,3,3] row_mask:0xf bank_mask:0xf
    v_cvt_pk_bf16_f32 v52, v52, v54
    v_min_u32 v52, -2, v52
    s_nop 1
    v_mov_b32_dpp v53, v52 row_shl:2 row_mask:0xf bank_mask:0xf
    v_mov_b32_dpp v54, v52 row_shl:4 row_mask:0xf bank_mask:0xf
    v_mov_b32_dpp v55, v52 row_shl:6 row_mask:0xf bank_mask:0xf
    buffer_store_dwordx4 v[52:55], v157, s[12:15], s55 offen sc1
    s_mov_b32 s55, s62
    s_cmp_eq_u32 s87, 1
    s_mov_b32 s87, 0
    s_cbranch_scc1 L_t2pre_53
    s_branch L_fin_40
L_role3_42:
    s_waitcnt vmcnt(30)
    s_sub_u32 s90, s2, 200
    s_mov_b32 s44, s16
    s_mov_b32 s45, s17
    s_mov_b32 s46, 2560
    s_mov_b32 s47, 0x20000
    v_and_b32 v152, 31, v1
    v_lshrrev_b32 v153, 5, v1
    v_mul_u32_u24 v154, 1280, v153
    v_lshl_add_u32 v154, v152, 1, v154
    s_lshl_b32 s92, s90, 6
    buffer_load_ushort v88, v154, s[44:47], s92 offen
    v_mov_b32 v159, 2146435072
    v_cndmask_b32 v154, v154, v159, s[64:65]
    v_and_b32 v155, 1, v1
    v_lshrrev_b32 v156, 1, v1
    v_lshl_add_u32 v155, v155, 5, v156
    v_lshlrev_b32 v155, 2, v155
    v_add_u32 v155, 50944, v155
    s_lshl_b32 s51, s48, 8
    s_add_u32 s51, s51, 50944
    v_lshl_add_u32 v156, v1, 2, s51
    v_and_b32 v157, 1, v1
    v_mul_u32_u24 v157, 3072, v157
    v_lshrrev_b32 v158, 4, v1
    v_lshl_add_u32 v157, v158, 4, v157
    v_and_b32 v158, 14, v1
    v_cmp_eq_u32 vcc, 0, v158
    s_nop 1
    v_cndmask_b32 v157, v159, v157, vcc
    s_mul_i32 s91, s48, 768
    s_add_u32 s91, s91, 6279168
    v_lshlrev_b32 v152, 4, v152
    s_mov_b32 s44, s34
    s_mov_b32 s45, s35
    s_mov_b32 s46, 2560
    s_mov_b32 s47, 0x20000
    s_cmp_eq_u32 s48, 0
    s_cselect_b32 s62, s92, 2146435072
    s_mov_b32 s87, 1
    s_mov_b32 s55, 2146435072
    v_mov_b32 v89, 0
    s_nop 0
    s_branch L_t3db_57
L_t3top_61:
    s_cmp_lg_u32 s48, 0
    s_cbranch_scc1 L_t3pb_56
    s_lshl_b32 s50, s90, 9
    s_add_u32 s50, s50, 655360
L_t3pa_58:
    s_mov_b32 s51, s50
    buffer_load_dwordx4 v[104:107], v152, s[12:15], s51 offen sc1
    s_add_u32 s51, s51, 10240
    buffer_load_dwordx4 v[108:111], v152, s[12:15], s51 offen sc1
    s_add_u32 s51, s51, 10240
    buffer_load_dwordx4 v[112:115], v152, s[12:15], s51 offen sc1
    s_add_u32 s51, s51, 10240
    buffer_load_dwordx4 v[116:119], v152, s[12:15], s51 offen sc1
    s_add_u32 s51, s51, 10240
    buffer_load_dwordx4 v[120:123], v152, s[12:15], s51 offen sc1
    s_add_u32 s51, s51, 10240
    buffer_load_dwordx4 v[124:127], v152, s[12:15], s51 offen sc1
    s_add_u32 s51, s51, 10240
    buffer_load_dwordx4 v[128:131], v152, s[12:15], s51 offen sc1
    s_add_u32 s51, s51, 10240
    buffer_load_dwordx4 v[132:135], v152, s[12:15], s51 offen sc1
    s_waitcnt vmcnt(0)
    v_bitop3_b32 v69, v106, v110, s57 bitop3:0x7e
    v_bitop3_b32 v70, v114, v118, s57 bitop3:0x7e
    v_bitop3_b32 v71, v122, v126, s57 bitop3:0x7e
    v_or3_b32 v69, v69, v70, v71
    v_bitop3_b32 v70, v130, v134, s57 bitop3:0x7e
    v_or_b32 v69, v69, v70
    v_cmp_ne_u32 s[76:77], 0, v69
    s_nop 0
    s_cmp_lg_u64 s[76:77], 0
    s_nop 1
    s_cbranch_scc0 L_t3da_59
    s_add_u32 s60, s60, 1
    s_cmp_lt_u32 s60, 131072
    s_sleep 4
    s_cbranch_scc1 L_t3pa_58
    v_mov_b32 v68, 80
    buffer_atomic_add v26, v68, s[40:43], 0 offen sc1
L_t3da_59:
    v_cndmask_b32 v104, v105, v104, s[74:75]
    v_cndmask_b32 v108, v109, v108, s[74:75]
    v_cndmask_b32 v112, v113, v112, s[74:75]
    v_cndmask_b32 v116, v117, v116, s[74:75]
    v_cndmask_b32 v120, v121, v120, s[74:75]
    v_cndmask_b32 v124, v125, v124, s[74:75]
    v_cndmask_b32 v128, v129, v128, s[74:75]
    v_cndmask_b32 v132, v133, v132, s[74:75]
    v_add_f32 v104, v108, v104
    v_add_f32 v112, v116, v112
    v_add_f32 v120, v124, v120
    v_add_f32 v128, v132, v128
    v_add_f32 v104, v104, v112
    v_add_f32 v104, v104, v120
    v_add_f32 v104, v104, v128
    v_cvt_pk_bf16_f32 v104, v104, v104
    v_and_b32 v104, 0xffff0000, v104
    v_lshlrev_b32 v89, 16, v88
    v_add_f32 v89, v89, v104
    v_cvt_pk_bf16_f32 v89, v89, v89
    v_and_b32 v89, 0xffff0000, v89
L_t3pb_56:
    buffer_load_dwordx4 v[104:107], v157, s[12:15], s91 offen offset:0 sc1
    buffer_load_dwordx4 v[108:111], v157, s[12:15], s91 offen offset:64 sc1
    buffer_load_dwordx4 v[112:115], v157, s[12:15], s91 offen offset:128 sc1
    buffer_load_dwordx4 v[116:119], v157, s[12:15], s91 offen offset:192 sc1
    buffer_load_dwordx4 v[120:123], v157, s[12:15], s91 offen offset:256 sc1
    buffer_load_dwordx4 v[124:127], v157, s[12:15], s91 offen offset:320 sc1
    buffer_load_dwordx4 v[128:131], v157, s[12:15], s91 offen offset:384 sc1
    buffer_load_dwordx4 v[132:135], v157, s[12:15], s91 offen offset:448 sc1
    buffer_load_dwordx4 v[136:139], v157, s[12:15], s91 offen offset:512 sc1
    buffer_load_dwordx4 v[140:143], v157, s[12:15], s91 offen offset:576 sc1
    buffer_load_dwordx4 v[144:147], v157, s[12:15], s91 offen offset:640 sc1
    buffer_load_dwordx4 v[148:151], v157, s[12:15], s91 offen offset:704 sc1
    s_waitcnt vmcnt(9)
    v_mfma_f32_16x16x32_bf16 v[52:55], v[104:107], v[160:163], 0
    v_mfma_f32_16x16x32_bf16 v[56:59], v[104:107], v[164:167], 0
    v_max3_u32 v76, v104, v105, v106
    v_mov_b32 v77, v107
    v_mfma_f32_16x16x32_bf16 v[60:63], v[108:111], v[168:171], 0
    v_mfma_f32_16x16x32_bf16 v[64:67], v[108:111], v[172:175], 0
    v_max3_u32 v76, v76, v108, v109
    v_max3_u32 v77, v77, v110, v111
    v_mfma_f32_16x16x32_bf16 v[52:55], v[112:115], v[176:179], v[52:55]
    v_mfma_f32_16x16x32_bf16 v[56:59], v[112:115], v[180:183], v[56:59]
    v_max3_u32 v76, v76, v112, v113
    v_max3_u32 v77, v77, v114, v115
    s_waitcnt vmcnt(6)
    v_mfma_f32_16x16x32_bf16 v[60:63], v[116:119], v[184:187], v[60:63]
    v_mfma_f32_16x16x32_bf16 v[64:67], v[116:119], v[188:191], v[64:67]
    v_max3_u32 v76, v76, v116, v117
    v_max3_u32 v77, v77, v118, v119
    v_mfma_f32_16x16x32_bf16 v[52:55], v[120:123], v[192:195], v[52:55]
    v_mfma_f32_16x16x32_bf16 v[56:59], v[120:123], v[196:199], v[56:59]
    v_max3_u32 v76, v76, v120, v121
    v_max3_u32 v77, v77, v122, v123
    v_mfma_f32_16x16x32_bf16 v[60:63], v[124:127], v[200:203], v[60:63]
    v_mfma_f32_16x16x32_bf16 v[64:67], v[124:127], v[204:207], v[64:67]
    v_max3_u32 v76, v76, v124, v125
    v_max3_u32 v77, v77, v126, v127
    s_waitcnt vmcnt(3)
    v_mfma_f32_16x16x32_bf16 v[52:55], v[128:131], v[208:211], v[52:55]
    v_mfma_f32_16x16x32_bf16 v[56:59], v[128:131], v[212:215], v[56:59]
    v_max3_u32 v76, v76, v128, v129
    v_max3_u32 v77, v77, v130, v131
    v_mfma_f32_16x16x32_bf16 v[60:63], v[132:135], v[216:219], v[60:63]
    v_mfma_f32_16x16x32_bf16 v[64:67], v[132:135], v[220:223], v[64:67]
    v_max3_u32 v76, v76, v132, v133
    v_max3_u32 v77, v77, v134, v135
    v_mfma_f32_16x16x32_bf16 v[52:55], v[136:139], v[224:227], v[52:55]
    v_mfma_f32_16x16x32_bf16 v[56:59], v[136:139], v[228:231], v[56:59]
    v_max3_u32 v76, v76, v136, v137
    v_max3_u32 v77, v77, v138, v139
    s_waitcnt vmcnt(0)
    v_mfma_f32_16x16x32_bf16 v[60:63], v[140:143], v[232:235], v[60:63]
    v_mfma_f32_16x16x32_bf16 v[64:67], v[140:143], v[236:239], v[64:67]
    v_max3_u32 v76, v76, v140, v141
    v_max3_u32 v77, v77, v142, v143
    v_mfma_f32_16x16x32_bf16 v[52:55], v[144:147], v[240:243], v[52:55]
    v_mfma_f32_16x16x32_bf16 v[56:59], v[144:147], v[244:247], v[56:59]
    v_max3_u32 v76, v76, v144, v145
    v_max3_u32 v77, v77, v146, v147
    v_mfma_f32_16x16x32_bf16 v[60:63], v[148:151], v[248:251], v[60:63]
    v_mfma_f32_16x16x32_bf16 v[64:67], v[148:151], v[252:255], v[64:67]
    v_max3_u32 v76, v76, v148, v149
    v_max3_u32 v77, v77, v150, v151
    v_max_u32 v76, v76, v77
    v_cmp_eq_u32 s[76:77], -1, v76
    s_nop 0
    s_cmp_eq_u64 s[76:77], 0
    s_nop 1
    s_cbranch_scc1 L_t3db_57
    s_cmp_eq_u32 s87, 1
    s_cbranch_scc1 L_t3db_57
    s_add_u32 s60, s60, 1
    s_cmp_lt_u32 s60, 131072
    s_cbranch_scc1 L_t3pb_56
    v_mov_b32 v68, 84
    buffer_atomic_add v26, v68, s[40:43], 0 offen sc1
L_t3db_57:
    v_add_f32 v52, v52, v60
    v_add_f32 v53, v53, v61
    v_add_f32 v56, v56, v64
    v_add_f32 v57, v57, v65
    s_mov_b64 exec, 0xffff
    ds_write2_b32 v156, v52, v53 offset0:0 offset1:16
    ds_write2_b32 v156, v56, v57 offset0:32 offset1:48
    s_mov_b64 exec, -1
    s_waitcnt lgkmcnt(0)
    s_barrier
    ds_read2st64_b32 v[52:53], v155 offset0:0 offset1:1
    ds_read2st64_b32 v[54:55], v155 offset0:2 offset1:3
    s_waitcnt lgkmcnt(0)
    v_add_f32 v52, v52, v53
    v_add_f32 v54, v54, v55
    v_add_f32 v52, v52, v54
    v_cvt_pk_bf16_f32 v52, v52, v52
    v_and_b32 v52, 0xffff0000, v52
    v_add_f32 v52, v52, v89
    s_nop 1
    v_mov_b32_dpp v53, v52 quad_perm:[1,1,3,3] row_mask:0xf bank_mask:0xf
    v_cvt_pk_bf16_f32 v52, v52, v53
    buffer_store_dword v52, v154, s[44:47], s55 offen sc1
    s_cmp_eq_u32 s87, 0
    s_cbranch_scc1 L_t3fin_60
    s_mov_b32 s87, 0
    s_mov_b32 s55, s62
    s_barrier
    s_branch L_t3top_61
L_t3fin_60:
    s_cmp_eq_u32 s90, 0
    s_cselect_b32 s50, 0, 2146435072
    v_mov_b32 v75, s57
    buffer_store_dword v75, v16, s[12:15], s50 offen sc1
L_fin_40:
L_end_sequential_preLN__mha_block_cached__geglu_ffn__decode_kernel:
    s_endpgm
L_hook_19:
    s_cmp_eq_u32 s3, 4
    s_cbranch_scc1 L_b1_18
    s_cmp_eq_u32 s39, 1
    s_cbranch_scc1 L_hret_20
L_wblk_17:
    s_mov_b32 s39, 1
    s_cmp_lt_u32 s2, 200
    s_cbranch_scc1 L_wt1_62
    s_lshl_b32 s50, s48, 12
    s_add_u32 s50, s50, 55040
    v_add_u32 v156, s50, v17
    v_lshrrev_b32 v157, 4, v1
    v_lshlrev_b32 v157, 9, v157
    v_and_b32 v66, 15, v1
    v_lshlrev_b32 v66, 2, v66
    v_add3_u32 v157, v157, v66, s50
    ds_write_b128 v156, v[160:163] offset:0
    ds_write_b128 v156, v[164:167] offset:1024
    ds_write_b128 v156, v[168:171] offset:2048
    ds_write_b128 v156, v[172:175] offset:3072
    ds_read_b32 v160, v157 offset:0
    ds_read_b32 v164, v157 offset:64
    ds_read_b32 v161, v157 offset:128
    ds_read_b32 v165, v157 offset:192
    ds_read_b32 v162, v157 offset:256
    ds_read_b32 v166, v157 offset:320
    ds_read_b32 v163, v157 offset:384
    ds_read_b32 v167, v157 offset:448
    s_waitcnt lgkmcnt(0)
    ds_read_b32 v168, v157 offset:2048
    ds_read_b32 v172, v157 offset:2112
    ds_read_b32 v169, v157 offset:2176
    ds_read_b32 v173, v157 offset:2240
    ds_read_b32 v170, v157 offset:2304
    ds_read_b32 v174, v157 offset:2368
    ds_read_b32 v171, v157 offset:2432
    ds_read_b32 v175, v157 offset:2496
    s_waitcnt lgkmcnt(0)
    v_perm_b32 v66, v164, v160, s88
    v_perm_b32 v164, v164, v160, s89
    v_mov_b32 v160, v66
    v_perm_b32 v67, v165, v161, s88
    v_perm_b32 v165, v165, v161, s89
    v_mov_b32 v161, v67
    v_perm_b32 v66, v166, v162, s88
    v_perm_b32 v166, v166, v162, s89
    v_mov_b32 v162, v66
    v_perm_b32 v67, v167, v163, s88
    v_perm_b32 v167, v167, v163, s89
    v_mov_b32 v163, v67
    v_perm_b32 v66, v172, v168, s88
    v_perm_b32 v172, v172, v168, s89
    v_mov_b32 v168, v66
    v_perm_b32 v67, v173, v169, s88
    v_perm_b32 v173, v173, v169, s89
    v_mov_b32 v169, v67
    v_perm_b32 v66, v174, v170, s88
    v_perm_b32 v174, v174, v170, s89
    v_mov_b32 v170, v66
    v_perm_b32 v67, v175, v171, s88
    v_perm_b32 v175, v175, v171, s89
    v_mov_b32 v171, v67
    ds_write_b128 v156, v[176:179] offset:0
    ds_write_b128 v156, v[180:183] offset:1024
    ds_write_b128 v156, v[184:187] offset:2048
    ds_write_b128 v156, v[188:191] offset:3072
    ds_read_b32 v176, v157 offset:0
    ds_read_b32 v180, v157 offset:64
    ds_read_b32 v177, v157 offset:128
    ds_read_b32 v181, v157 offset:192
    ds_read_b32 v178, v157 offset:256
    ds_read_b32 v182, v157 offset:320
    ds_read_b32 v179, v157 offset:384
    ds_read_b32 v183, v157 offset:448
    s_waitcnt lgkmcnt(0)
    ds_read_b32 v184, v157 offset:2048
    ds_read_b32 v188, v157 offset:2112
    ds_read_b32 v185, v157 offset:2176
    ds_read_b32 v189, v157 offset:2240
    ds_read_b32 v186, v157 offset:2304
    ds_read_b32 v190, v157 offset:2368
    ds_read_b32 v187, v157 offset:2432
    ds_read_b32 v191, v157 offset:2496
    s_waitcnt lgkmcnt(0)
    v_perm_b32 v66, v180, v176, s88
    v_perm_b32 v180, v180, v176, s89
    v_mov_b32 v176, v66
    v_perm_b32 v67, v181, v177, s88
    v_perm_b32 v181, v181, v177, s89
    v_mov_b32 v177, v67
    v_perm_b32 v66, v182, v178, s88
    v_perm_b32 v182, v182, v178, s89
    v_mov_b32 v178, v66
    v_perm_b32 v67, v183, v179, s88
    v_perm_b32 v183, v183, v179, s89
    v_mov_b32 v179, v67
    v_perm_b32 v66, v188, v184, s88
    v_perm_b32 v188, v188, v184, s89
    v_mov_b32 v184, v66
    v_perm_b32 v67, v189, v185, s88
    v_perm_b32 v189, v189, v185, s89
    v_mov_b32 v185, v67
    v_perm_b32 v66, v190, v186, s88
    v_perm_b32 v190, v190, v186, s89
    v_mov_b32 v186, v66
    v_perm_b32 v67, v191, v187, s88
    v_perm_b32 v191, v191, v187, s89
    v_mov_b32 v187, v67
    ds_write_b128 v156, v[192:195] offset:0
    ds_write_b128 v156, v[196:199] offset:1024
    ds_write_b128 v156, v[200:203] offset:2048
    ds_write_b128 v156, v[204:207] offset:3072
    ds_read_b32 v192, v157 offset:0
    ds_read_b32 v196, v157 offset:64
    ds_read_b32 v193, v157 offset:128
    ds_read_b32 v197, v157 offset:192
    ds_read_b32 v194, v157 offset:256
    ds_read_b32 v198, v157 offset:320
    ds_read_b32 v195, v157 offset:384
    ds_read_b32 v199, v157 offset:448
    s_waitcnt lgkmcnt(0)
    ds_read_b32 v200, v157 offset:2048
    ds_read_b32 v204, v157 offset:2112
    ds_read_b32 v201, v157 offset:2176
    ds_read_b32 v205, v157 offset:2240
    ds_read_b32 v202, v157 offset:2304
    ds_read_b32 v206, v157 offset:2368
    ds_read_b32 v203, v157 offset:2432
    ds_read_b32 v207, v157 offset:2496
    s_waitcnt lgkmcnt(0)
    v_perm_b32 v66, v196, v192, s88
    v_perm_b32 v196, v196, v192, s89
    v_mov_b32 v192, v66
    v_perm_b32 v67, v197, v193, s88
    v_perm_b32 v197, v197, v193, s89
    v_mov_b32 v193, v67
    v_perm_b32 v66, v198, v194, s88
    v_perm_b32 v198, v198, v194, s89
    v_mov_b32 v194, v66
    v_perm_b32 v67, v199, v195, s88
    v_perm_b32 v199, v199, v195, s89
    v_mov_b32 v195, v67
    v_perm_b32 v66, v204, v200, s88
    v_perm_b32 v204, v204, v200, s89
    v_mov_b32 v200, v66
    v_perm_b32 v67, v205, v201, s88
    v_perm_b32 v205, v205, v201, s89
    v_mov_b32 v201, v67
    v_perm_b32 v66, v206, v202, s88
    v_perm_b32 v206, v206, v202, s89
    v_mov_b32 v202, v66
    v_perm_b32 v67, v207, v203, s88
    v_perm_b32 v207, v207, v203, s89
    v_mov_b32 v203, v67
    ds_write_b128 v156, v[208:211] offset:0
    ds_write_b128 v156, v[212:215] offset:1024
    ds_write_b128 v156, v[216:219] offset:2048
    ds_write_b128 v156, v[220:223] offset:3072
    ds_read_b32 v208, v157 offset:0
    ds_read_b32 v212, v157 offset:64
    ds_read_b32 v209, v157 offset:128
    ds_read_b32 v213, v157 offset:192
    ds_read_b32 v210, v157 offset:256
    ds_read_b32 v214, v157 offset:320
    ds_read_b32 v211, v157 offset:384
    ds_read_b32 v215, v157 offset:448
    s_waitcnt lgkmcnt(0)
    ds_read_b32 v216, v157 offset:2048
    ds_read_b32 v220, v157 offset:2112
    ds_read_b32 v217, v157 offset:2176
    ds_read_b32 v221, v157 offset:2240
    ds_read_b32 v218, v157 offset:2304
    ds_read_b32 v222, v157 offset:2368
    ds_read_b32 v219, v157 offset:2432
    ds_read_b32 v223, v157 offset:2496
    s_waitcnt lgkmcnt(0)
    v_perm_b32 v66, v212, v208, s88
    v_perm_b32 v212, v212, v208, s89
    v_mov_b32 v208, v66
    v_perm_b32 v67, v213, v209, s88
    v_perm_b32 v213, v213, v209, s89
    v_mov_b32 v209, v67
    v_perm_b32 v66, v214, v210, s88
    v_perm_b32 v214, v214, v210, s89
    v_mov_b32 v210, v66
    v_perm_b32 v67, v215, v211, s88
    v_perm_b32 v215, v215, v211, s89
    v_mov_b32 v211, v67
    v_perm_b32 v66, v220, v216, s88
    v_perm_b32 v220, v220, v216, s89
    v_mov_b32 v216, v66
    v_perm_b32 v67, v221, v217, s88
    v_perm_b32 v221, v221, v217, s89
    v_mov_b32 v217, v67
    v_perm_b32 v66, v222, v218, s88
    v_perm_b32 v222, v222, v218, s89
    v_mov_b32 v218, v66
    v_perm_b32 v67, v223, v219, s88
    v_perm_b32 v223, v223, v219, s89
    v_mov_b32 v219, v67
    ds_write_b128 v156, v[224:227] offset:0
    ds_write_b128 v156, v[228:231] offset:1024
    ds_write_b128 v156, v[232:235] offset:2048
    ds_write_b128 v156, v[236:239] offset:3072
    ds_read_b32 v224, v157 offset:0
    ds_read_b32 v228, v157 offset:64
    ds_read_b32 v225, v157 offset:128
    ds_read_b32 v229, v157 offset:192
    ds_read_b32 v226, v157 offset:256
    ds_read_b32 v230, v157 offset:320
    ds_read_b32 v227, v157 offset:384
    ds_read_b32 v231, v157 offset:448
    s_waitcnt lgkmcnt(0)
    ds_read_b32 v232, v157 offset:2048
    ds_read_b32 v236, v157 offset:2112
    ds_read_b32 v233, v157 offset:2176
    ds_read_b32 v237, v157 offset:2240
    ds_read_b32 v234, v157 offset:2304
    ds_read_b32 v238, v157 offset:2368
    ds_read_b32 v235, v157 offset:2432
    ds_read_b32 v239, v157 offset:2496
    s_waitcnt lgkmcnt(0)
    v_perm_b32 v66, v228, v224, s88
    v_perm_b32 v228, v228, v224, s89
    v_mov_b32 v224, v66
    v_perm_b32 v67, v229, v225, s88
    v_perm_b32 v229, v229, v225, s89
    v_mov_b32 v225, v67
    v_perm_b32 v66, v230, v226, s88
    v_perm_b32 v230, v230, v226, s89
    v_mov_b32 v226, v66
    v_perm_b32 v67, v231, v227, s88
    v_perm_b32 v231, v231, v227, s89
    v_mov_b32 v227, v67
    v_perm_b32 v66, v236, v232, s88
    v_perm_b32 v236, v236, v232, s89
    v_mov_b32 v232, v66
    v_perm_b32 v67, v237, v233, s88
    v_perm_b32 v237, v237, v233, s89
    v_mov_b32 v233, v67
    v_perm_b32 v66, v238, v234, s88
    v_perm_b32 v238, v238, v234, s89
    v_mov_b32 v234, v66
    v_perm_b32 v67, v239, v235, s88
    v_perm_b32 v239, v239, v235, s89
    v_mov_b32 v235, v67
    ds_write_b128 v156, v[240:243] offset:0
    ds_write_b128 v156, v[244:247] offset:1024
    ds_write_b128 v156, v[248:251] offset:2048
    ds_write_b128 v156, v[252:255] offset:3072
    ds_read_b32 v240, v157 offset:0
    ds_read_b32 v244, v157 offset:64
    ds_read_b32 v241, v157 offset:128
    ds_read_b32 v245, v157 offset:192
    ds_read_b32 v242, v157 offset:256
    ds_read_b32 v246, v157 offset:320
    ds_read_b32 v243, v157 offset:384
    ds_read_b32 v247, v157 offset:448
    s_waitcnt lgkmcnt(0)
    ds_read_b32 v248, v157 offset:2048
    ds_read_b32 v252, v157 offset:2112
    ds_read_b32 v249, v157 offset:2176
    ds_read_b32 v253, v157 offset:2240
    ds_read_b32 v250, v157 offset:2304
    ds_read_b32 v254, v157 offset:2368
    ds_read_b32 v251, v157 offset:2432
    ds_read_b32 v255, v157 offset:2496
    s_waitcnt lgkmcnt(0)
    v_perm_b32 v66, v244, v240, s88
    v_perm_b32 v244, v244, v240, s89
    v_mov_b32 v240, v66
    v_perm_b32 v67, v245, v241, s88
    v_perm_b32 v245, v245, v241, s89
    v_mov_b32 v241, v67
    v_perm_b32 v66, v246, v242, s88
    v_perm_b32 v246, v246, v242, s89
    v_mov_b32 v242, v66
    v_perm_b32 v67, v247, v243, s88
    v_perm_b32 v247, v247, v243, s89
    v_mov_b32 v243, v67
    v_perm_b32 v66, v252, v248, s88
    v_perm_b32 v252, v252, v248, s89
    v_mov_b32 v248, v66
    v_perm_b32 v67, v253, v249, s88
    v_perm_b32 v253, v253, v249, s89
    v_mov_b32 v249, v67
    v_perm_b32 v66, v254, v250, s88
    v_perm_b32 v254, v254, v250, s89
    v_mov_b32 v250, v66
    v_perm_b32 v67, v255, v251, s88
    v_perm_b32 v255, v255, v251, s89
    v_mov_b32 v251, v67
    s_nop 0
    s_branch L_hret_20
L_wt1_62:
    s_lshl_b32 s50, s48, 12
    s_add_u32 s50, s50, 55040
    v_add_u32 v156, s50, v17
    v_lshrrev_b32 v157, 4, v1
    v_lshlrev_b32 v157, 10, v157
    v_and_b32 v66, 15, v1
    v_lshlrev_b32 v66, 2, v66
    v_add3_u32 v157, v157, v66, s50
    ds_write_b128 v156, v[160:163] offset:0
    ds_write_b128 v156, v[164:167] offset:1024
    ds_write_b128 v156, v[168:171] offset:2048
    ds_write_b128 v156, v[172:175] offset:3072
    ds_read_b32 v160, v157 offset:0
    ds_read_b32 v164, v157 offset:128
    ds_read_b32 v161, v157 offset:256
    ds_read_b32 v165, v157 offset:384
    ds_read_b32 v162, v157 offset:512
    ds_read_b32 v166, v157 offset:640
    ds_read_b32 v163, v157 offset:768
    ds_read_b32 v167, v157 offset:896
    s_waitcnt lgkmcnt(0)
    ds_read_b32 v168, v157 offset:64
    ds_read_b32 v172, v157 offset:192
    ds_read_b32 v169, v157 offset:320
    ds_read_b32 v173, v157 offset:448
    ds_read_b32 v170, v157 offset:576
    ds_read_b32 v174, v157 offset:704
    ds_read_b32 v171, v157 offset:832
    ds_read_b32 v175, v157 offset:960
    s_waitcnt lgkmcnt(0)
    v_perm_b32 v66, v164, v160, s88
    v_perm_b32 v164, v164, v160, s89
    v_mov_b32 v160, v66
    v_perm_b32 v67, v165, v161, s88
    v_perm_b32 v165, v165, v161, s89
    v_mov_b32 v161, v67
    v_perm_b32 v66, v166, v162, s88
    v_perm_b32 v166, v166, v162, s89
    v_mov_b32 v162, v66
    v_perm_b32 v67, v167, v163, s88
    v_perm_b32 v167, v167, v163, s89
    v_mov_b32 v163, v67
    v_perm_b32 v66, v172, v168, s88
    v_perm_b32 v172, v172, v168, s89
    v_mov_b32 v168, v66
    v_perm_b32 v67, v173, v169, s88
    v_perm_b32 v173, v173, v169, s89
    v_mov_b32 v169, v67
    v_perm_b32 v66, v174, v170, s88
    v_perm_b32 v174, v174, v170, s89
    v_mov_b32 v170, v66
    v_perm_b32 v67, v175, v171, s88
    v_perm_b32 v175, v175, v171, s89
    v_mov_b32 v171, v67
    ds_write_b128 v156, v[176:179] offset:0
    ds_write_b128 v156, v[180:183] offset:1024
    ds_write_b128 v156, v[184:187] offset:2048
    ds_write_b128 v156, v[188:191] offset:3072
    ds_read_b32 v176, v157 offset:0
    ds_read_b32 v180, v157 offset:128
    ds_read_b32 v177, v157 offset:256
    ds_read_b32 v181, v157 offset:384
    ds_read_b32 v178, v157 offset:512
    ds_read_b32 v182, v157 offset:640
    ds_read_b32 v179, v157 offset:768
    ds_read_b32 v183, v157 offset:896
    s_waitcnt lgkmcnt(0)
    ds_read_b32 v184, v157 offset:64
    ds_read_b32 v188, v157 offset:192
    ds_read_b32 v185, v157 offset:320
    ds_read_b32 v189, v157 offset:448
    ds_read_b32 v186, v157 offset:576
    ds_read_b32 v190, v157 offset:704
    ds_read_b32 v187, v157 offset:832
    ds_read_b32 v191, v157 offset:960
    s_waitcnt lgkmcnt(0)
    v_perm_b32 v66, v180, v176, s88
    v_perm_b32 v180, v180, v176, s89
    v_mov_b32 v176, v66
    v_perm_b32 v67, v181, v177, s88
    v_perm_b32 v181, v181, v177, s89
    v_mov_b32 v177, v67
    v_perm_b32 v66, v182, v178, s88
    v_perm_b32 v182, v182, v178, s89
    v_mov_b32 v178, v66
    v_perm_b32 v67, v183, v179, s88
    v_perm_b32 v183, v183, v179, s89
    v_mov_b32 v179, v67
    v_perm_b32 v66, v188, v184, s88
    v_perm_b32 v188, v188, v184, s89
    v_mov_b32 v184, v66
    v_perm_b32 v67, v189, v185, s88
    v_perm_b32 v189, v189, v185, s89
    v_mov_b32 v185, v67
    v_perm_b32 v66, v190, v186, s88
    v_perm_b32 v190, v190, v186, s89
    v_mov_b32 v186, v66
    v_perm_b32 v67, v191, v187, s88
    v_perm_b32 v191, v191, v187, s89
    v_mov_b32 v187, v67
    ds_write_b128 v156, v[192:195] offset:0
    ds_write_b128 v156, v[196:199] offset:1024
    ds_write_b128 v156, v[200:203] offset:2048
    ds_write_b128 v156, v[204:207] offset:3072
    ds_read_b32 v192, v157 offset:0
    ds_read_b32 v196, v157 offset:128
    ds_read_b32 v193, v157 offset:256
    ds_read_b32 v197, v157 offset:384
    ds_read_b32 v194, v157 offset:512
    ds_read_b32 v198, v157 offset:640
    ds_read_b32 v195, v157 offset:768
    ds_read_b32 v199, v157 offset:896
    s_waitcnt lgkmcnt(0)
    ds_read_b32 v200, v157 offset:64
    ds_read_b32 v204, v157 offset:192
    ds_read_b32 v201, v157 offset:320
    ds_read_b32 v205, v157 offset:448
    ds_read_b32 v202, v157 offset:576
    ds_read_b32 v206, v157 offset:704
    ds_read_b32 v203, v157 offset:832
    ds_read_b32 v207, v157 offset:960
    s_waitcnt lgkmcnt(0)
    v_perm_b32 v66, v196, v192, s88
    v_perm_b32 v196, v196, v192, s89
    v_mov_b32 v192, v66
    v_perm_b32 v67, v197, v193, s88
    v_perm_b32 v197, v197, v193, s89
    v_mov_b32 v193, v67
    v_perm_b32 v66, v198, v194, s88
    v_perm_b32 v198, v198, v194, s89
    v_mov_b32 v194, v66
    v_perm_b32 v67, v199, v195, s88
    v_perm_b32 v199, v199, v195, s89
    v_mov_b32 v195, v67
    v_perm_b32 v66, v204, v200, s88
    v_perm_b32 v204, v204, v200, s89
    v_mov_b32 v200, v66
    v_perm_b32 v67, v205, v201, s88
    v_perm_b32 v205, v205, v201, s89
    v_mov_b32 v201, v67
    v_perm_b32 v66, v206, v202, s88
    v_perm_b32 v206, v206, v202, s89
    v_mov_b32 v202, v66
    v_perm_b32 v67, v207, v203, s88
    v_perm_b32 v207, v207, v203, s89
    v_mov_b32 v203, v67
    ds_write_b128 v156, v[208:211] offset:0
    ds_write_b128 v156, v[212:215] offset:1024
    ds_write_b128 v156, v[216:219] offset:2048
    ds_write_b128 v156, v[220:223] offset:3072
    ds_read_b32 v208, v157 offset:0
    ds_read_b32 v212, v157 offset:128
    ds_read_b32 v209, v157 offset:256
    ds_read_b32 v213, v157 offset:384
    ds_read_b32 v210, v157 offset:512
    ds_read_b32 v214, v157 offset:640
    ds_read_b32 v211, v157 offset:768
    ds_read_b32 v215, v157 offset:896
    s_waitcnt lgkmcnt(0)
    ds_read_b32 v216, v157 offset:64
    ds_read_b32 v220, v157 offset:192
    ds_read_b32 v217, v157 offset:320
    ds_read_b32 v221, v157 offset:448
    ds_read_b32 v218, v157 offset:576
    ds_read_b32 v222, v157 offset:704
    ds_read_b32 v219, v157 offset:832
    ds_read_b32 v223, v157 offset:960
    s_waitcnt lgkmcnt(0)
    v_perm_b32 v66, v212, v208, s88
    v_perm_b32 v212, v212, v208, s89
    v_mov_b32 v208, v66
    v_perm_b32 v67, v213, v209, s88
    v_perm_b32 v213, v213, v209, s89
    v_mov_b32 v209, v67
    v_perm_b32 v66, v214, v210, s88
    v_perm_b32 v214, v214, v210, s89
    v_mov_b32 v210, v66
    v_perm_b32 v67, v215, v211, s88
    v_perm_b32 v215, v215, v211, s89
    v_mov_b32 v211, v67
    v_perm_b32 v66, v220, v216, s88
    v_perm_b32 v220, v220, v216, s89
    v_mov_b32 v216, v66
    v_perm_b32 v67, v221, v217, s88
    v_perm_b32 v221, v221, v217, s89
    v_mov_b32 v217, v67
    v_perm_b32 v66, v222, v218, s88
    v_perm_b32 v222, v222, v218, s89
    v_mov_b32 v218, v66
    v_perm_b32 v67, v223, v219, s88
    v_perm_b32 v223, v223, v219, s89
    v_mov_b32 v219, v67
    ds_write_b128 v156, v[224:227] offset:0
    ds_write_b128 v156, v[228:231] offset:1024
    ds_write_b128 v156, v[232:235] offset:2048
    ds_write_b128 v156, v[236:239] offset:3072
    ds_read_b32 v224, v157 offset:0
    ds_read_b32 v228, v157 offset:128
    ds_read_b32 v225, v157 offset:256
    ds_read_b32 v229, v157 offset:384
    ds_read_b32 v226, v157 offset:512
    ds_read_b32 v230, v157 offset:640
    ds_read_b32 v227, v157 offset:768
    ds_read_b32 v231, v157 offset:896
    s_waitcnt lgkmcnt(0)
    ds_read_b32 v232, v157 offset:64
    ds_read_b32 v236, v157 offset:192
    ds_read_b32 v233, v157 offset:320
    ds_read_b32 v237, v157 offset:448
    ds_read_b32 v234, v157 offset:576
    ds_read_b32 v238, v157 offset:704
    ds_read_b32 v235, v157 offset:832
    ds_read_b32 v239, v157 offset:960
    s_waitcnt lgkmcnt(0)
    v_perm_b32 v66, v228, v224, s88
    v_perm_b32 v228, v228, v224, s89
    v_mov_b32 v224, v66
    v_perm_b32 v67, v229, v225, s88
    v_perm_b32 v229, v229, v225, s89
    v_mov_b32 v225, v67
    v_perm_b32 v66, v230, v226, s88
    v_perm_b32 v230, v230, v226, s89
    v_mov_b32 v226, v66
    v_perm_b32 v67, v231, v227, s88
    v_perm_b32 v231, v231, v227, s89
    v_mov_b32 v227, v67
    v_perm_b32 v66, v236, v232, s88
    v_perm_b32 v236, v236, v232, s89
    v_mov_b32 v232, v66
    v_perm_b32 v67, v237, v233, s88
    v_perm_b32 v237, v237, v233, s89
    v_mov_b32 v233, v67
    v_perm_b32 v66, v238, v234, s88
    v_perm_b32 v238, v238, v234, s89
    v_mov_b32 v234, v66
    v_perm_b32 v67, v239, v235, s88
    v_perm_b32 v239, v239, v235, s89
    v_mov_b32 v235, v67
    ds_write_b128 v156, v[240:243] offset:0
    ds_write_b128 v156, v[244:247] offset:1024
    ds_write_b128 v156, v[248:251] offset:2048
    ds_write_b128 v156, v[252:255] offset:3072
    ds_read_b32 v240, v157 offset:0
    ds_read_b32 v244, v157 offset:128
    ds_read_b32 v241, v157 offset:256
    ds_read_b32 v245, v157 offset:384
    ds_read_b32 v242, v157 offset:512
    ds_read_b32 v246, v157 offset:640
    ds_read_b32 v243, v157 offset:768
    ds_read_b32 v247, v157 offset:896
    s_waitcnt lgkmcnt(0)
    ds_read_b32 v248, v157 offset:64
    ds_read_b32 v252, v157 offset:192
    ds_read_b32 v249, v157 offset:320
    ds_read_b32 v253, v157 offset:448
    ds_read_b32 v250, v157 offset:576
    ds_read_b32 v254, v157 offset:704
    ds_read_b32 v251, v157 offset:832
    ds_read_b32 v255, v157 offset:960
    s_waitcnt lgkmcnt(0)
    v_perm_b32 v66, v244, v240, s88
    v_perm_b32 v244, v244, v240, s89
    v_mov_b32 v240, v66
    v_perm_b32 v67, v245, v241, s88
    v_perm_b32 v245, v245, v241, s89
    v_mov_b32 v241, v67
    v_perm_b32 v66, v246, v242, s88
    v_perm_b32 v246, v246, v242, s89
    v_mov_b32 v242, v66
    v_perm_b32 v67, v247, v243, s88
    v_perm_b32 v247, v247, v243, s89
    v_mov_b32 v243, v67
    v_perm_b32 v66, v252, v248, s88
    v_perm_b32 v252, v252, v248, s89
    v_mov_b32 v248, v66
    v_perm_b32 v67, v253, v249, s88
    v_perm_b32 v253, v253, v249, s89
    v_mov_b32 v249, v67
    v_perm_b32 v66, v254, v250, s88
    v_perm_b32 v254, v254, v250, s89
    v_mov_b32 v250, v66
    v_perm_b32 v67, v255, v251, s88
    v_perm_b32 v255, v255, v251, s89
    v_mov_b32 v251, v67
    s_cmp_lt_u32 s2, 176
    s_cbranch_scc1 L_hret_20
    ds_write_b128 v156, a[192:195] offset:0
    ds_write_b128 v156, a[196:199] offset:1024
    ds_write_b128 v156, a[200:203] offset:2048
    ds_write_b128 v156, a[204:207] offset:3072
    ds_read_b32 v28, v157 offset:0
    ds_read_b32 v29, v157 offset:128
    ds_read_b32 v30, v157 offset:256
    ds_read_b32 v31, v157 offset:384
    ds_read_b32 v32, v157 offset:512
    ds_read_b32 v33, v157 offset:640
    ds_read_b32 v34, v157 offset:768
    ds_read_b32 v35, v157 offset:896
    s_waitcnt lgkmcnt(0)
    ds_read_b32 v36, v157 offset:64
    ds_read_b32 v37, v157 offset:192
    ds_read_b32 v38, v157 offset:320
    ds_read_b32 v39, v157 offset:448
    ds_read_b32 v40, v157 offset:576
    ds_read_b32 v41, v157 offset:704
    ds_read_b32 v42, v157 offset:832
    ds_read_b32 v43, v157 offset:960
    s_waitcnt lgkmcnt(0)
    v_perm_b32 v66, v29, v28, s88
    v_perm_b32 v67, v29, v28, s89
    v_accvgpr_write_b32 a192, v66
    v_accvgpr_write_b32 a196, v67
    v_perm_b32 v66, v31, v30, s88
    v_perm_b32 v67, v31, v30, s89
    v_accvgpr_write_b32 a193, v66
    v_accvgpr_write_b32 a197, v67
    v_perm_b32 v66, v33, v32, s88
    v_perm_b32 v67, v33, v32, s89
    v_accvgpr_write_b32 a194, v66
    v_accvgpr_write_b32 a198, v67
    v_perm_b32 v66, v35, v34, s88
    v_perm_b32 v67, v35, v34, s89
    v_accvgpr_write_b32 a195, v66
    v_accvgpr_write_b32 a199, v67
    v_perm_b32 v66, v37, v36, s88
    v_perm_b32 v67, v37, v36, s89
    v_accvgpr_write_b32 a200, v66
    v_accvgpr_write_b32 a204, v67
    v_perm_b32 v66, v39, v38, s88
    v_perm_b32 v67, v39, v38, s89
    v_accvgpr_write_b32 a201, v66
    v_accvgpr_write_b32 a205, v67
    v_perm_b32 v66, v41, v40, s88
    v_perm_b32 v67, v41, v40, s89
    v_accvgpr_write_b32 a202, v66
    v_accvgpr_write_b32 a206, v67
    v_perm_b32 v66, v43, v42, s88
    v_perm_b32 v67, v43, v42, s89
    v_accvgpr_write_b32 a203, v66
    v_accvgpr_write_b32 a207, v67
    ds_write_b128 v156, a[208:211] offset:0
    ds_write_b128 v156, a[212:215] offset:1024
    ds_write_b128 v156, a[216:219] offset:2048
    ds_write_b128 v156, a[220:223] offset:3072
    ds_read_b32 v28, v157 offset:0
    ds_read_b32 v29, v157 offset:128
    ds_read_b32 v30, v157 offset:256
    ds_read_b32 v31, v157 offset:384
    ds_read_b32 v32, v157 offset:512
    ds_read_b32 v33, v157 offset:640
    ds_read_b32 v34, v157 offset:768
    ds_read_b32 v35, v157 offset:896
    s_waitcnt lgkmcnt(0)
    ds_read_b32 v36, v157 offset:64
    ds_read_b32 v37, v157 offset:192
    ds_read_b32 v38, v157 offset:320
    ds_read_b32 v39, v157 offset:448
    ds_read_b32 v40, v157 offset:576
    ds_read_b32 v41, v157 offset:704
    ds_read_b32 v42, v157 offset:832
    ds_read_b32 v43, v157 offset:960
    s_waitcnt lgkmcnt(0)
    v_perm_b32 v66, v29, v28, s88
    v_perm_b32 v67, v29, v28, s89
    v_accvgpr_write_b32 a208, v66
    v_accvgpr_write_b32 a212, v67
    v_perm_b32 v66, v31, v30, s88
    v_perm_b32 v67, v31, v30, s89
    v_accvgpr_write_b32 a209, v66
    v_accvgpr_write_b32 a213, v67
    v_perm_b32 v66, v33, v32, s88
    v_perm_b32 v67, v33, v32, s89
    v_accvgpr_write_b32 a210, v66
    v_accvgpr_write_b32 a214, v67
    v_perm_b32 v66, v35, v34, s88
    v_perm_b32 v67, v35, v34, s89
    v_accvgpr_write_b32 a211, v66
    v_accvgpr_write_b32 a215, v67
    v_perm_b32 v66, v37, v36, s88
    v_perm_b32 v67, v37, v36, s89
    v_accvgpr_write_b32 a216, v66
    v_accvgpr_write_b32 a220, v67
    v_perm_b32 v66, v39, v38, s88
    v_perm_b32 v67, v39, v38, s89
    v_accvgpr_write_b32 a217, v66
    v_accvgpr_write_b32 a221, v67
    v_perm_b32 v66, v41, v40, s88
    v_perm_b32 v67, v41, v40, s89
    v_accvgpr_write_b32 a218, v66
    v_accvgpr_write_b32 a222, v67
    v_perm_b32 v66, v43, v42, s88
    v_perm_b32 v67, v43, v42, s89
    v_accvgpr_write_b32 a219, v66
    v_accvgpr_write_b32 a223, v67
    ds_write_b128 v156, a[224:227] offset:0
    ds_write_b128 v156, a[228:231] offset:1024
    ds_write_b128 v156, a[232:235] offset:2048
    ds_write_b128 v156, a[236:239] offset:3072
    ds_read_b32 v28, v157 offset:0
    ds_read_b32 v29, v157 offset:128
    ds_read_b32 v30, v157 offset:256
    ds_read_b32 v31, v157 offset:384
    ds_read_b32 v32, v157 offset:512
    ds_read_b32 v33, v157 offset:640
    ds_read_b32 v34, v157 offset:768
    ds_read_b32 v35, v157 offset:896
    s_waitcnt lgkmcnt(0)
    ds_read_b32 v36, v157 offset:64
    ds_read_b32 v37, v157 offset:192
    ds_read_b32 v38, v157 offset:320
    ds_read_b32 v39, v157 offset:448
    ds_read_b32 v40, v157 offset:576
    ds_read_b32 v41, v157 offset:704
    ds_read_b32 v42, v157 offset:832
    ds_read_b32 v43, v157 offset:960
    s_waitcnt lgkmcnt(0)
    v_perm_b32 v66, v29, v28, s88
    v_perm_b32 v67, v29, v28, s89
    v_accvgpr_write_b32 a224, v66
    v_accvgpr_write_b32 a228, v67
    v_perm_b32 v66, v31, v30, s88
    v_perm_b32 v67, v31, v30, s89
    v_accvgpr_write_b32 a225, v66
    v_accvgpr_write_b32 a229, v67
    v_perm_b32 v66, v33, v32, s88
    v_perm_b32 v67, v33, v32, s89
    v_accvgpr_write_b32 a226, v66
    v_accvgpr_write_b32 a230, v67
    v_perm_b32 v66, v35, v34, s88
    v_perm_b32 v67, v35, v34, s89
    v_accvgpr_write_b32 a227, v66
    v_accvgpr_write_b32 a231, v67
    v_perm_b32 v66, v37, v36, s88
    v_perm_b32 v67, v37, v36, s89
    v_accvgpr_write_b32 a232, v66
    v_accvgpr_write_b32 a236, v67
    v_perm_b32 v66, v39, v38, s88
    v_perm_b32 v67, v39, v38, s89
    v_accvgpr_write_b32 a233, v66
    v_accvgpr_write_b32 a237, v67
    v_perm_b32 v66, v41, v40, s88
    v_perm_b32 v67, v41, v40, s89
    v_accvgpr_write_b32 a234, v66
    v_accvgpr_write_b32 a238, v67
    v_perm_b32 v66, v43, v42, s88
    v_perm_b32 v67, v43, v42, s89
    v_accvgpr_write_b32 a235, v66
    v_accvgpr_write_b32 a239, v67
    ds_write_b128 v156, a[240:243] offset:0
    ds_write_b128 v156, a[244:247] offset:1024
    ds_write_b128 v156, a[248:251] offset:2048
    ds_write_b128 v156, a[252:255] offset:3072
    ds_read_b32 v28, v157 offset:0
    ds_read_b32 v29, v157 offset:128
    ds_read_b32 v30, v157 offset:256
    ds_read_b32 v31, v157 offset:384
    ds_read_b32 v32, v157 offset:512
    ds_read_b32 v33, v157 offset:640
    ds_read_b32 v34, v157 offset:768
    ds_read_b32 v35, v157 offset:896
    s_waitcnt lgkmcnt(0)
    ds_read_b32 v36, v157 offset:64
    ds_read_b32 v37, v157 offset:192
    ds_read_b32 v38, v157 offset:320
    ds_read_b32 v39, v157 offset:448
    ds_read_b32 v40, v157 offset:576
    ds_read_b32 v41, v157 offset:704
    ds_read_b32 v42, v157 offset:832
    ds_read_b32 v43, v157 offset:960
    s_waitcnt lgkmcnt(0)
    v_perm_b32 v66, v29, v28, s88
    v_perm_b32 v67, v29, v28, s89
    v_accvgpr_write_b32 a240, v66
    v_accvgpr_write_b32 a244, v67
    v_perm_b32 v66, v31, v30, s88
    v_perm_b32 v67, v31, v30, s89
    v_accvgpr_write_b32 a241, v66
    v_accvgpr_write_b32 a245, v67
    v_perm_b32 v66, v33, v32, s88
    v_perm_b32 v67, v33, v32, s89
    v_accvgpr_write_b32 a242, v66
    v_accvgpr_write_b32 a246, v67
    v_perm_b32 v66, v35, v34, s88
    v_perm_b32 v67, v35, v34, s89
    v_accvgpr_write_b32 a243, v66
    v_accvgpr_write_b32 a247, v67
    v_perm_b32 v66, v37, v36, s88
    v_perm_b32 v67, v37, v36, s89
    v_accvgpr_write_b32 a248, v66
    v_accvgpr_write_b32 a252, v67
    v_perm_b32 v66, v39, v38, s88
    v_perm_b32 v67, v39, v38, s89
    v_accvgpr_write_b32 a249, v66
    v_accvgpr_write_b32 a253, v67
    v_perm_b32 v66, v41, v40, s88
    v_perm_b32 v67, v41, v40, s89
    v_accvgpr_write_b32 a250, v66
    v_accvgpr_write_b32 a254, v67
    v_perm_b32 v66, v43, v42, s88
    v_perm_b32 v67, v43, v42, s89
    v_accvgpr_write_b32 a251, v66
    v_accvgpr_write_b32 a255, v67
    s_nop 0
    s_branch L_hret_20
L_b1_18:
    s_waitcnt lgkmcnt(0)
    s_barrier
    v_and_b32 v68, 3, v1
    v_lshlrev_b32 v69, 5, v68
    ds_read_b128 v[76:79], v69 offset:33280
    ds_read_b128 v[80:83], v69 offset:33296
    v_lshlrev_b32 v68, 12, v68
    v_mov_b32 v69, 2146435072
    v_cmp_gt_u32 vcc, 4, v0
    s_nop 1
    v_cndmask_b32 v68, v69, v68, vcc
    s_lshl_b32 s50, s2, 4
    s_add_u32 s50, s50, 786432
    v_mov_b32 v86, s57
    s_waitcnt lgkmcnt(0)
    v_max3_f32 v84, v76, v78, v80
    v_max_f32 v84, v84, v82
    v_sub_f32 v76, v76, v84
    v_sub_f32 v78, v78, v84
    v_sub_f32 v80, v80, v84
    v_sub_f32 v82, v82, v84
    v_mul_f32 v76, 0x3fb8aa3b, v76
    v_mul_f32 v78, 0x3fb8aa3b, v78
    v_mul_f32 v80, 0x3fb8aa3b, v80
    v_mul_f32 v82, 0x3fb8aa3b, v82
    v_exp_f32 v76, v76
    v_exp_f32 v78, v78
    v_exp_f32 v80, v80
    v_exp_f32 v82, v82
    v_mul_f32 v85, v76, v77
    v_fmac_f32 v85, v78, v79
    v_fmac_f32 v85, v80, v81
    v_fmac_f32 v85, v82, v83
    buffer_store_dwordx4 v[84:87], v68, s[12:15], s50 offen sc1
L_hret_20:
    s_sub_u32 s50, s2, 96
    s_cmp_lt_u32 s50, 80
    s_cbranch_scc1 L_back_22
    s_sub_u32 s50, s2, 176
    s_cmp_lt_u32 s50, 44
    s_cbranch_scc1 L_back_23
    s_branch L_back_21
L_sslow_25:
    s_sleep 4
    s_waitcnt vmcnt(32)
    s_add_u32 s51, s49, 0
    s_lshr_b32 s51, s51, 7
    s_lshl_b32 s51, s51, 9
    s_add_u32 s51, s51, 786432
    buffer_load_dwordx4 v[104:107], v24, s[12:15], s51 offen sc1
    s_waitcnt vmcnt(0)
    s_add_u32 s60, s60, 1
    s_cmp_lt_u32 s60, 131072
    s_cbranch_scc1 L_schk_27
    v_mov_b32 v87, 68
    buffer_atomic_add v26, v87, s[40:43], 0 offen sc1
    s_branch L_sback_26
L_sslow_28:
    s_sleep 4
    s_waitcnt vmcnt(32)
    s_add_u32 s51, s49, 0
    s_lshr_b32 s51, s51, 7
    s_lshl_b32 s51, s51, 9
    s_add_u32 s51, s51, 786432
    buffer_load_dwordx4 v[104:107], v24, s[12:15], s51 offen sc1
    s_waitcnt vmcnt(0)
    s_add_u32 s60, s60, 1
    s_cmp_lt_u32 s60, 131072
    s_cbranch_scc1 L_schk_30
    v_mov_b32 v87, 68
    buffer_atomic_add v26, v87, s[40:43], 0 offen sc1
    s_branch L_sback_29
L_vslow_32:
    s_cmp_ge_u32 s49, 8192
    s_cbranch_scc1 L_vback_33
    s_sleep 4
    s_waitcnt vmcnt(32)
    s_lshr_b32 s51, s82, 7
    s_lshl_b32 s51, s51, 9
    s_add_u32 s51, s51, 786432
    s_lshl_b32 s52, s82, 9
    s_add_u32 s52, s52, 1048576
    s_cmp_lt_u32 s82, 8192
    s_cselect_b32 s51, s51, 2146435072
    s_cselect_b32 s52, s52, 2146435072
    buffer_load_dwordx4 v[88:91], v24, s[12:15], s51 offen sc1
    buffer_load_dwordx4 v[92:95], v18, s[12:15], s52 offen sc1
    s_waitcnt vmcnt(0)
    s_add_u32 s60, s60, 1
    s_cmp_lt_u32 s60, 131072
    s_cbranch_scc1 L_vchk_34
    v_mov_b32 v87, 68
    buffer_atomic_add v26, v87, s[40:43], 0 offen sc1
    s_branch L_vback_33
L_vslow_36:
    s_cmp_ge_u32 s49, 8192
    s_cbranch_scc1 L_vback_37
    s_sleep 4
    s_waitcnt vmcnt(32)
    s_lshr_b32 s51, s83, 7
    s_lshl_b32 s51, s51, 9
    s_add_u32 s51, s51, 786432
    s_lshl_b32 s52, s83, 9
    s_add_u32 s52, s52, 1048576
    s_cmp_lt_u32 s83, 8192
    s_cselect_b32 s51, s51, 2146435072
    s_cselect_b32 s52, s52, 2146435072
    buffer_load_dwordx4 v[96:99], v24, s[12:15], s51 offen sc1
    buffer_load_dwordx4 v[100:103], v18, s[12:15], s52 offen sc1
    s_waitcnt vmcnt(0)
    s_add_u32 s60, s60, 1
    s_cmp_lt_u32 s60, 131072
    s_cbranch_scc1 L_vchk_38
    v_mov_b32 v87, 68
    buffer_atomic_add v26, v87, s[40:43], 0 offen sc1
    s_branch L_vback_37
.section .rodata,"a"
.p2align 6
.amdhsa_kernel sequential_preLN__mha_block_cached__geglu_ffn__decode_kernel
  .amdhsa_next_free_vgpr 512
  .amdhsa_next_free_sgpr 102
  .amdhsa_accum_offset 256
  .amdhsa_group_segment_fixed_size 0
  .amdhsa_kernarg_size 96
  .amdhsa_user_sgpr_count 2
  .amdhsa_user_sgpr_kernarg_segment_ptr 1
  .amdhsa_system_sgpr_workgroup_id_x 1
.end_amdhsa_kernel
```
